```python
import torch

def _softmax(x, axis=-1):
    return torch.softmax(x, dim=axis)
def _gelu(x):
    return torch.nn.functional.gelu(x, approximate="tanh")
def _silu(x):
    return torch.nn.functional.silu(x)
def _sigmoid(x):
    return torch.sigmoid(x)
def _layernorm(x, axis=-1, eps=1e-5):
    m = x.mean(dim=axis, keepdim=True)
    v = x.var(dim=axis, keepdim=True, unbiased=False)
    return (x - m) / torch.sqrt(v + eps)
def _scatter_add(tgt, idx, src, axis=0):
    return tgt.clone().index_add_(axis, idx, src)
def _segment_sum(src, seg, n):
    out = torch.zeros((n,) + src.shape[1:], dtype=src.dtype)
    return out.index_add_(0, seg, src)
def _pad(x, pw):
    flat = tuple(v for pair in reversed(pw) for v in pair)
    return torch.nn.functional.pad(x, flat)

kernel_name = 'standalone__batchnorm__sampling'

def setup_inputs():

    _w = (lambda a: (lambda t: t.to(torch.bfloat16) if t.is_floating_point() else t)(torch.as_tensor(a)))
    B, S, C = 1024, 4, 576
    K = 3
    return {
        "x": _w((lambda *s: torch.randn(*s, dtype=torch.bfloat16) * 0.05)(B, S, C)),
        "w": _w((lambda *s: torch.randn(*s, dtype=torch.bfloat16) * 0.05)(K, C, C) * (1.0 / (K * C) ** 0.5)),
        "mean": _w((lambda *s: torch.randn(*s, dtype=torch.bfloat16) * 0.05)(C) * 0.1),
        "var": _w(torch.abs((lambda *s: torch.randn(*s, dtype=torch.bfloat16) * 0.05)(C)) + 0.5),
        "g": _w((lambda *s: torch.randn(*s, dtype=torch.bfloat16) * 0.05)(C) + 1.0),
        "b": _w((lambda *s: torch.randn(*s, dtype=torch.bfloat16) * 0.05)(C) * 0.1),
    }

def reference(x, w, mean, var, g, b):
    K = 3
    P = K // 2
    S = x.shape[1]
    xp = _pad(x, ((0, 0), (P, P), (0, 0)))
    y = sum(torch.einsum('bsc,cd->bsd', xp[:, k:k + S, :], w[k]) for k in range(K))
    inv_std = 1.0 / torch.sqrt(var + 1e-5)
    y = (y - mean) * (g * inv_std) + b
    return _silu(y)
```

```asm
; @launch grid=(256,1,1) block=(512,1,1) lds=141568
.amdgcn_target "amdgcn-amd-amdhsa--gfx950"
.text
.globl standalone__batchnorm__sampling_kernel
.p2align 12
.p2align 8
.type standalone__batchnorm__sampling_kernel,@function
standalone__batchnorm__sampling_kernel:
    s_load_dwordx2 s[24:25], s[0:1], 8
    s_load_dwordx2 s[20:21], s[0:1], 0
    s_lshr_b32 s37, s2, 3
    s_getpc_b64 s[30:31]
L_pc:
    v_and_b32 v2, 0x180, v0
    v_lshl_add_u32 v2, s37, 9, v2
    v_min_u32 v2, L_end-L_pc, v2
    global_load_dword v255, v2, s[30:31]
    v_readfirstlane_b32 s3, v0
    s_and_b32 s36, s2, 7
    s_lshl_b32 s36, s36, 2
    s_lshr_b32 s36, 913645828, s36
    s_and_b32 s36, s36, 7
    s_mul_i32 s35, s36, 60
    s_mul_i32 s38, s36, 80
    s_sub_u32 s38, s38, 320
    s_cmp_lt_u32 s36, 4
    s_cselect_b32 s35, s35, s38
    s_mov_b32 s38, 85984320
    s_cselect_b32 s38, 1967412, s38
    s_cmp_eq_u32 s36, 7
    s_cselect_b32 s38, 1181981, s38
    s_cselect_b32 s39, 32, 40
    s_bfe_u32 s36, s38, 0x80010
    s_cmp_ge_u32 s37, s36
    s_cbranch_scc1 L_end
    s_and_b32 s33, s38, 0xff
    s_mul_i32 s33, s33, s37
    s_lshr_b32 s33, s33, 8
    s_bfe_u32 s36, s38, 0x80008
    s_mul_i32 s36, s36, s33
    s_sub_u32 s34, s37, s36
    s_lshr_b32 s38, s38, 24
    s_add_u32 s34, s34, s38
    s_mul_i32 s36, s33, s39
    s_lshl2_add_u32 s35, s35, s36
    s_add_u32 s22, s35, s39
    s_min_u32 s22, s22, 0x400
    s_mulk_i32 s22, 4608
    s_lshr_b32 s32, s3, 6
    v_and_b32 v1, 63, v0
    s_cmp_ge_u32 s32, 4
    s_cbranch_scc1 L_consumer
    s_add_u32 s17, s33, s34
    s_mul_i32 s37, s17, 43
    s_lshr_b32 s37, s37, 7
    v_lshrrev_b32 v2, 3, v1
    s_mul_i32 s37, s37, 3
    v_and_b32 v3, 7, v1
    s_sub_u32 s17, s17, s37
    s_and_b32 s49, s2, 7
    s_cmp_eq_u32 s49, 5
    s_cselect_b32 s49, 31, 0x1e0
    s_lshr_b32 s49, s49, s34
    s_and_b32 s49, s49, 1
    s_mul_i32 s16, s49, 6
    s_add_u32 s16, s16, s17
    v_and_b32 v9, 2, v2
    s_and_b32 s38, s32, 1
    v_mul_u32_u24 v8, 1152, v2
    s_lshl_b32 s39, s38, 2
    v_xor_b32 v9, v9, v3
    s_mul_i32 s36, s32, 72
    v_xor_b32 v9, s39, v9
    s_add_u32 s36, s36, s34
    v_lshl_add_u32 v9, v9, 4, v8
    s_lshl_b32 s36, s36, 7
    s_mov_b32 s26, 1990656
    v_add_u32 v15, s36, v9
    s_mov_b32 s27, 0x20000
    v_add_u32 v16, 662528, v15
    s_mul_i32 s43, s16, 73728
    v_add_u32 v17, 1325056, v15
    s_mul_i32 s42, s32, 6144
    v_lshrrev_b32 v4, 4, v1
    s_add_u32 s42, s42, 62208
    v_xor_b32 v5, v3, v4
    s_mov_b32 m0, s42
    v_lshlrev_b32 v5, 4, v5
    s_mov_b32 s23, s27
    v_lshl_add_u32 v6, v8, 2, v5
    s_waitcnt lgkmcnt(0)
    buffer_load_dwordx4 v15, s[24:27], s43 offen lds
    s_lshl2_add_u32 s37, s35, s32
    s_mulk_i32 s37, 1152
    buffer_load_dwordx4 v16, s[24:27], s43 offen offset:1024 lds
    v_add_u32 v10, s37, v6
    s_mul_i32 s40, s32, 5120
    v_xor_b32 v11, 64, v10
    s_lshl_b32 s36, s16, 7
    buffer_load_dwordx4 v17, s[24:27], s43 offen offset:2048 lds
    s_mov_b32 m0, s40
    v_add_u32 v11, 35840, v11
    buffer_load_dwordx4 v10, s[20:23], s36 offen lds
    v_add_u32 v12, 90112, v10
    s_lshr_b32 s37, s32, 1
    buffer_load_dwordx4 v11, s[20:23], s36 offen offset:1024 lds
    v_add_u32 v13, 90112, v11
    s_mul_i32 s37, s37, 10
    s_add_u32 s37, s37, s38
    buffer_load_dwordx4 v12, s[20:23], s36 offen offset:2048 lds
    s_lshl1_add_u32 s37, s37, s35
    s_add_u32 s37, s37, 16
    s_mulk_i32 s37, 4608
    s_lshl_b32 s39, s38, 6
    buffer_load_dwordx4 v13, s[20:23], s36 offen offset:3072 lds
    v_xor_b32 v9, s39, v5
    s_add_u32 m0, s40, 4096
    v_add3_u32 v14, v9, v8, s37
    buffer_load_dwordx4 v14, s[20:23], s36 offen lds
    s_add_u32 m0, s42, 3072
    s_add_u32 s43, s43, 36864
    buffer_load_dwordx4 v15, s[24:27], s43 offen lds
    buffer_load_dwordx4 v16, s[24:27], s43 offen offset:1024 lds
    buffer_load_dwordx4 v17, s[24:27], s43 offen offset:2048 lds
    s_load_dwordx8 s[8:15], s[0:1], 16
    s_mul_i32 s49, s49, 3
    s_add_u32 s17, s17, s49
    s_mov_b32 s16, 2270577201
    s_cmp_eq_u32 s17, 1
    s_cselect_b32 s16, 2255827970, s16
    s_cmp_eq_u32 s17, 2
    s_cselect_b32 s16, 2019840784, s16
    s_cmp_eq_u32 s17, 3
    s_cselect_b32 s16, 558909495, s16
    s_cmp_eq_u32 s17, 4
    s_cselect_b32 s16, 538260584, s16
    s_cmp_eq_u32 s17, 5
    s_cselect_b32 s16, 302273398, s16
    s_barrier
    s_cmp_lg_u32 s32, 3
    s_cbranch_scc1 L_lnop
    s_lshl_b32 s37, s34, 7
    v_lshl_add_u32 v24, v1, 1, s37
    s_waitcnt lgkmcnt(0)
    global_load_ushort v20, v24, s[8:9]
    global_load_ushort v21, v24, s[10:11]
    global_load_ushort v22, v24, s[12:13]
    global_load_ushort v23, v24, s[14:15]
L_lnop:
    s_mov_b32 s44, 1
    s_mov_b32 s47, 0
L_lloop:
    s_add_u32 s47, s47, 1
    s_cmp_eq_u32 s47, 3
    s_cselect_b32 s47, 0, s47
    s_mov_b32 s45, 20736
    s_cselect_b32 s45, 4294925824, s45
    s_mov_b32 s46, 24576
    s_cselect_b32 s46, 4294918144, s46
    s_add_u32 s40, s40, s45
    s_add_u32 s42, s42, s46
    s_and_b32 s43, s16, 15
    s_lshl_b32 s36, s43, 7
    s_mul_i32 s43, s43, 73728
    s_lshr_b32 s16, s16, 4
    s_mov_b32 m0, s40
    s_nop 0
    buffer_load_dwordx4 v10, s[20:23], s36 offen lds
    buffer_load_dwordx4 v11, s[20:23], s36 offen offset:1024 lds
    buffer_load_dwordx4 v12, s[20:23], s36 offen offset:2048 lds
    buffer_load_dwordx4 v13, s[20:23], s36 offen offset:3072 lds
    s_add_u32 m0, s40, 4096
    s_add_u32 s44, s44, 1
    buffer_load_dwordx4 v14, s[20:23], s36 offen lds
    s_mov_b32 m0, s42
    s_nop 0
    buffer_load_dwordx4 v15, s[24:27], s43 offen lds
    buffer_load_dwordx4 v16, s[24:27], s43 offen offset:1024 lds
    buffer_load_dwordx4 v17, s[24:27], s43 offen offset:2048 lds
    s_cmp_gt_u32 s44, 8
    s_cbranch_scc1 L_lnb
    s_waitcnt vmcnt(8)
    s_barrier
L_lnb:
    s_add_u32 m0, s42, 3072
    s_add_u32 s43, s43, 36864
    buffer_load_dwordx4 v15, s[24:27], s43 offen lds
    buffer_load_dwordx4 v16, s[24:27], s43 offen offset:1024 lds
    buffer_load_dwordx4 v17, s[24:27], s43 offen offset:2048 lds
    s_cmp_lt_u32 s44, 9
    s_cbranch_scc1 L_lloop
    s_waitcnt vmcnt(11)
    s_barrier
    s_cmp_lg_u32 s32, 3
    s_cbranch_scc1 L_lfin
    v_lshlrev_b32 v20, 16, v20
    v_lshlrev_b32 v21, 16, v21
    v_lshlrev_b32 v22, 16, v22
    v_lshlrev_b32 v23, 16, v23
    v_add_f32 v21, 0x3727c5ac, v21
    v_rsq_f32 v21, v21
    v_mul_f32 v22, 0xbfb8aa3b, v22
    v_mul_f32 v23, 0xbfb8aa3b, v23
    v_mul_f32 v22, v21, v22
    v_fma_f32 v23, -v20, v22, v23
    v_lshlrev_b32 v2, 2, v1
    v_add_u32 v2, 136960, v2
    s_waitcnt vmcnt(0)
    ds_write_b32 v2, v22
    ds_write_b32 v2, v23 offset:256
L_lfin:
    s_waitcnt vmcnt(0) lgkmcnt(0)
    s_barrier
    s_endpgm
L_consumer:
    s_load_dwordx2 s[28:29], s[0:1], 48
    s_setprio 3
    v_and_b32 v13, 15, v1
    v_lshrrev_b32 v14, 4, v1
    v_mov_b32 v16, 0
    v_mov_b32 v17, 0
    v_mov_b32 v18, 0
    v_mov_b32 v19, 0
    v_min_u32 v15, 2, v14
    v_mul_u32_u24 v15, 20736, v15
    v_lshl_add_u32 v15, v13, 4, v15
    ds_write_b128 v15, v[16:19] offset:20480
    s_sub_u32 s32, s32, 4
    s_lshr_b32 s36, s32, 1
    s_and_b32 s37, s32, 1
    s_lshl_b32 s39, s36, 11
    v_lshrrev_b32 v15, 1, v13
    v_xor_b32 v15, v15, v14
    v_lshlrev_b32 v15, 4, v15
    v_lshl_add_u32 v15, v13, 7, v15
    v_add_u32 v2, s39, v15
    v_xor_b32 v3, 64, v2
    s_mul_i32 s44, s36, 10240
    s_add_u32 s44, s44, 4096
    v_lshrrev_b32 v230, 3, v13
    v_lshl_add_u32 v230, v230, 12, s44
    v_add_u32 v252, v230, v15
    v_xor_b32 v253, 64, v252
    v_add_u32 v15, 3, v13
    v_bfi_b32 v15, 3, v15, v13
    v_lshrrev_b32 v228, 1, v15
    v_xor_b32 v228, v228, v14
    v_lshlrev_b32 v228, 4, v228
    v_lshl_add_u32 v228, v15, 7, v228
    v_add_u32 v229, v230, v228
    v_and_b32 v228, 0xff, v228
    v_and_b32 v15, 3, v13
    v_cmp_eq_u32 vcc, 0, v15
    v_add_u32 v228, 20480, v228
    s_nop 0
    v_cndmask_b32 v4, v229, v228, vcc
    v_xor_b32 v5, 64, v4
    v_add_u32 v15, 1, v13
    v_bfi_b32 v15, 3, v15, v13
    v_lshrrev_b32 v228, 1, v15
    v_xor_b32 v228, v228, v14
    v_lshlrev_b32 v228, 4, v228
    v_lshl_add_u32 v228, v15, 7, v228
    v_add_u32 v229, v230, v228
    v_and_b32 v228, 0xff, v228
    v_and_b32 v15, 3, v13
    v_cmp_eq_u32 vcc, 3, v15
    v_add_u32 v228, 20480, v228
    s_nop 0
    v_cndmask_b32 v6, v229, v228, vcc
    v_xor_b32 v7, 64, v6
    v_lshrrev_b32 v15, 2, v13
    v_mul_u32_u24 v228, 6144, v14
    v_lshl_add_u32 v228, v15, 7, v228
    v_lshrrev_b32 v15, 1, v15
    v_and_b32 v229, 1, v14
    v_lshl_add_u32 v15, v229, 1, v15
    s_lshl_b32 s44, s37, 1
    v_xor_b32 v15, s44, v15
    v_lshl_add_u32 v228, v15, 5, v228
    v_and_b32 v15, 3, v13
    v_lshl_add_u32 v228, v15, 3, v228
    v_add_u32 v8, 62208, v228
    v_xor_b32 v9, 32, v8
    s_barrier
    s_mov_b64 exec, 0
    s_branch L_pad0
L_ret0:
    s_branch L_pad1
L_ret1:
    s_mov_b64 exec, -1
L_cpoll0:
    s_waitcnt lgkmcnt(0)
    s_barrier
    ds_read_b64_tr_b16 v[64:65], v8 offset:1024
    ds_read_b64_tr_b16 v[66:67], v8 offset:1536
    ds_read_b128 v[152:155], v2 offset:0
    ds_read_b64_tr_b16 v[72:73], v8 offset:2048
    ds_read_b64_tr_b16 v[74:75], v8 offset:2560
    ds_read_b128 v[156:159], v2 offset:5120
    ds_read_b64_tr_b16 v[88:89], v8 offset:4096
    ds_read_b64_tr_b16 v[90:91], v8 offset:4608
    ds_read_b128 v[180:183], v3 offset:0
    ds_read_b64_tr_b16 v[96:97], v8 offset:5120
    ds_read_b64_tr_b16 v[98:99], v8 offset:5632
    ds_read_b128 v[184:187], v3 offset:5120
    ds_read_b64_tr_b16 v[68:69], v9 offset:1024
    ds_read_b64_tr_b16 v[70:71], v9 offset:1536
    ds_read_b64_tr_b16 v[76:77], v9 offset:2048
    ds_read_b64_tr_b16 v[78:79], v9 offset:2560
    s_waitcnt lgkmcnt(13)
    v_mfma_f32_16x16x32_bf16 v[16:19], v[64:67], v[152:155], 0
    ds_read_b64_tr_b16 v[92:93], v9 offset:4096
    ds_read_b64_tr_b16 v[94:95], v9 offset:4608
    s_waitcnt lgkmcnt(12)
    v_mfma_f32_16x16x32_bf16 v[16:19], v[72:75], v[156:159], v[16:19]
    ds_read_b64_tr_b16 v[100:101], v9 offset:5120
    ds_read_b64_tr_b16 v[102:103], v9 offset:5632
    s_waitcnt lgkmcnt(11)
    v_mfma_f32_16x16x32_bf16 v[16:19], v[88:91], v[180:183], v[16:19]
    ds_read_b64_tr_b16 v[56:57], v8 offset:0
    ds_read_b64_tr_b16 v[58:59], v8 offset:512
    s_waitcnt lgkmcnt(10)
    v_mfma_f32_16x16x32_bf16 v[16:19], v[96:99], v[184:187], v[16:19]
    ds_read_b128 v[160:163], v2 offset:10240
    ds_read_b64_tr_b16 v[80:81], v8 offset:3072
    s_waitcnt lgkmcnt(10)
    v_mfma_f32_16x16x32_bf16 v[20:23], v[68:71], v[152:155], 0
    ds_read_b64_tr_b16 v[82:83], v8 offset:3584
    s_waitcnt lgkmcnt(9)
    v_mfma_f32_16x16x32_bf16 v[20:23], v[76:79], v[156:159], v[20:23]
    ds_read_b128 v[188:191], v3 offset:10240
    s_waitcnt lgkmcnt(8)
    v_mfma_f32_16x16x32_bf16 v[20:23], v[92:95], v[180:183], v[20:23]
    ds_read_b64_tr_b16 v[60:61], v9 offset:0
    s_waitcnt lgkmcnt(7)
    v_mfma_f32_16x16x32_bf16 v[20:23], v[100:103], v[184:187], v[20:23]
    ds_read_b64_tr_b16 v[62:63], v9 offset:512
    s_waitcnt lgkmcnt(6)
    v_mfma_f32_16x16x32_bf16 v[24:27], v[56:59], v[152:155], 0
    ds_read_b64_tr_b16 v[84:85], v9 offset:3072
    v_mfma_f32_16x16x32_bf16 v[24:27], v[64:67], v[156:159], v[24:27]
    ds_read_b64_tr_b16 v[86:87], v9 offset:3584
    s_waitcnt lgkmcnt(6)
    v_mfma_f32_16x16x32_bf16 v[24:27], v[72:75], v[160:163], v[24:27]
    ds_read_b128 v[164:167], v2 offset:15360
    s_waitcnt lgkmcnt(6)
    v_mfma_f32_16x16x32_bf16 v[24:27], v[80:83], v[180:183], v[24:27]
    ds_read_b128 v[192:195], v3 offset:15360
    v_mfma_f32_16x16x32_bf16 v[24:27], v[88:91], v[184:187], v[24:27]
    ds_read_b128 v[168:171], v4 offset:0
    s_waitcnt lgkmcnt(6)
    v_mfma_f32_16x16x32_bf16 v[24:27], v[96:99], v[188:191], v[24:27]
    ds_read_b128 v[172:175], v252 offset:0
    s_waitcnt lgkmcnt(6)
    v_mfma_f32_16x16x32_bf16 v[28:31], v[60:63], v[152:155], 0
    ds_read_b128 v[176:179], v6 offset:0
    v_mfma_f32_16x16x32_bf16 v[28:31], v[68:71], v[156:159], v[28:31]
    ds_read_b128 v[196:199], v5 offset:0
    v_mfma_f32_16x16x32_bf16 v[28:31], v[76:79], v[160:163], v[28:31]
    ds_read_b128 v[200:203], v253 offset:0
    s_waitcnt lgkmcnt(6)
    v_mfma_f32_16x16x32_bf16 v[28:31], v[84:87], v[180:183], v[28:31]
    ds_read_b128 v[204:207], v7 offset:0
    v_mfma_f32_16x16x32_bf16 v[28:31], v[92:95], v[184:187], v[28:31]
    s_mov_b32 s30, s22
    v_mfma_f32_16x16x32_bf16 v[28:31], v[100:103], v[188:191], v[28:31]
    s_mov_b32 s31, 0x20000
    v_mfma_f32_16x16x32_bf16 v[32:35], v[56:59], v[156:159], 0
    s_lshl_b32 s44, s37, 7
    v_mfma_f32_16x16x32_bf16 v[32:35], v[64:67], v[160:163], v[32:35]
    s_add_u32 s44, s44, 136960
    v_mfma_f32_16x16x32_bf16 v[32:35], v[72:75], v[164:167], v[32:35]
    v_lshl_add_u32 v12, v14, 4, s44
    v_mfma_f32_16x16x32_bf16 v[32:35], v[80:83], v[184:187], v[32:35]
    s_lshl_b32 s44, s32, 10
    v_mfma_f32_16x16x32_bf16 v[32:35], v[88:91], v[188:191], v[32:35]
    s_add_u32 s44, s44, 137472
    s_waitcnt lgkmcnt(0)
    v_mfma_f32_16x16x32_bf16 v[32:35], v[96:99], v[192:195], v[32:35]
    v_lshrrev_b32 v15, 1, v14
    v_mfma_f32_16x16x32_bf16 v[36:39], v[60:63], v[156:159], 0
    v_bfe_u32 v228, v13, 1, 2
    v_mfma_f32_16x16x32_bf16 v[36:39], v[68:71], v[160:163], v[36:39]
    v_xor_b32 v15, v15, v228
    v_mfma_f32_16x16x32_bf16 v[36:39], v[76:79], v[164:167], v[36:39]
    v_lshlrev_b32 v15, 4, v15
    v_mfma_f32_16x16x32_bf16 v[36:39], v[84:87], v[184:187], v[36:39]
    v_lshl_add_u32 v15, v13, 6, v15
    v_mfma_f32_16x16x32_bf16 v[36:39], v[92:95], v[188:191], v[36:39]
    v_and_b32 v228, 1, v14
    v_mfma_f32_16x16x32_bf16 v[36:39], v[100:103], v[192:195], v[36:39]
    v_lshl_add_u32 v15, v228, 3, v15
    v_mfma_f32_16x16x32_bf16 v[40:43], v[56:59], v[160:163], 0
    v_add_u32 v250, s44, v15
    v_mfma_f32_16x16x32_bf16 v[40:43], v[64:67], v[164:167], v[40:43]
    v_xor_b32 v254, 32, v250
    v_mfma_f32_16x16x32_bf16 v[40:43], v[80:83], v[188:191], v[40:43]
    v_lshl_add_u32 v251, v1, 4, s44
    v_mfma_f32_16x16x32_bf16 v[40:43], v[88:91], v[192:195], v[40:43]
    s_lshl_b32 s38, s34, 7
    v_mfma_f32_16x16x32_bf16 v[44:47], v[60:63], v[160:163], 0
    s_waitcnt lgkmcnt(0)
    s_barrier
    v_mfma_f32_16x16x32_bf16 v[44:47], v[68:71], v[164:167], v[44:47]
    ds_read_b64_tr_b16 v[112:113], v8 offset:25600
    ds_read_b64_tr_b16 v[114:115], v8 offset:26112
    v_mfma_f32_16x16x32_bf16 v[44:47], v[84:87], v[188:191], v[44:47]
    ds_read_b128 v[152:155], v2 offset:20736
    ds_read_b64_tr_b16 v[120:121], v8 offset:26624
    v_mfma_f32_16x16x32_bf16 v[44:47], v[92:95], v[192:195], v[44:47]
    ds_read_b64_tr_b16 v[122:123], v8 offset:27136
    ds_read_b128 v[156:159], v2 offset:25856
    v_mfma_f32_16x16x32_bf16 v[48:51], v[56:59], v[168:171], 0
    ds_read_b64_tr_b16 v[136:137], v8 offset:28672
    ds_read_b64_tr_b16 v[138:139], v8 offset:29184
    v_mfma_f32_16x16x32_bf16 v[48:51], v[64:67], v[172:175], v[48:51]
    ds_read_b128 v[180:183], v3 offset:20736
    ds_read_b64_tr_b16 v[144:145], v8 offset:29696
    v_mfma_f32_16x16x32_bf16 v[48:51], v[72:75], v[176:179], v[48:51]
    ds_read_b64_tr_b16 v[146:147], v8 offset:30208
    v_mfma_f32_16x16x32_bf16 v[48:51], v[80:83], v[196:199], v[48:51]
    ds_read_b128 v[184:187], v3 offset:25856
    v_mfma_f32_16x16x32_bf16 v[48:51], v[88:91], v[200:203], v[48:51]
    ds_read_b64_tr_b16 v[116:117], v9 offset:25600
    v_mfma_f32_16x16x32_bf16 v[48:51], v[96:99], v[204:207], v[48:51]
    ds_read_b64_tr_b16 v[118:119], v9 offset:26112
    v_mfma_f32_16x16x32_bf16 v[52:55], v[60:63], v[168:171], 0
    ds_read_b64_tr_b16 v[124:125], v9 offset:26624
    v_mfma_f32_16x16x32_bf16 v[52:55], v[68:71], v[172:175], v[52:55]
    ds_read_b64_tr_b16 v[126:127], v9 offset:27136
    v_mfma_f32_16x16x32_bf16 v[52:55], v[76:79], v[176:179], v[52:55]
    ds_read_b64_tr_b16 v[140:141], v9 offset:28672
    v_mfma_f32_16x16x32_bf16 v[52:55], v[84:87], v[196:199], v[52:55]
    ds_read_b64_tr_b16 v[142:143], v9 offset:29184
    v_mfma_f32_16x16x32_bf16 v[52:55], v[92:95], v[200:203], v[52:55]
    ds_read_b64_tr_b16 v[148:149], v9 offset:29696
    v_mfma_f32_16x16x32_bf16 v[52:55], v[100:103], v[204:207], v[52:55]
    ds_read_b64_tr_b16 v[150:151], v9 offset:30208
    s_waitcnt lgkmcnt(6)
    v_mfma_f32_16x16x32_bf16 v[16:19], v[112:115], v[152:155], v[16:19]
    ds_read_b64_tr_b16 v[104:105], v8 offset:24576
    v_mfma_f32_16x16x32_bf16 v[16:19], v[120:123], v[156:159], v[16:19]
    ds_read_b64_tr_b16 v[106:107], v8 offset:25088
    v_mfma_f32_16x16x32_bf16 v[16:19], v[136:139], v[180:183], v[16:19]
    ds_read_b128 v[160:163], v2 offset:30976
    v_mfma_f32_16x16x32_bf16 v[16:19], v[144:147], v[184:187], v[16:19]
    ds_read_b64_tr_b16 v[128:129], v8 offset:27648
    v_mfma_f32_16x16x32_bf16 v[20:23], v[116:119], v[152:155], v[20:23]
    ds_read_b64_tr_b16 v[130:131], v8 offset:28160
    s_waitcnt lgkmcnt(6)
    v_mfma_f32_16x16x32_bf16 v[20:23], v[124:127], v[156:159], v[20:23]
    ds_read_b128 v[188:191], v3 offset:30976
    v_mfma_f32_16x16x32_bf16 v[20:23], v[140:143], v[180:183], v[20:23]
    ds_read_b64_tr_b16 v[108:109], v9 offset:24576
    s_waitcnt lgkmcnt(6)
    v_mfma_f32_16x16x32_bf16 v[20:23], v[148:151], v[184:187], v[20:23]
    ds_read_b64_tr_b16 v[110:111], v9 offset:25088
    s_waitcnt lgkmcnt(6)
    v_mfma_f32_16x16x32_bf16 v[24:27], v[104:107], v[152:155], v[24:27]
    ds_read_b64_tr_b16 v[132:133], v9 offset:27648
    v_mfma_f32_16x16x32_bf16 v[24:27], v[112:115], v[156:159], v[24:27]
    ds_read_b64_tr_b16 v[134:135], v9 offset:28160
    s_waitcnt lgkmcnt(6)
    v_mfma_f32_16x16x32_bf16 v[24:27], v[120:123], v[160:163], v[24:27]
    ds_read_b128 v[164:167], v2 offset:36096
    s_waitcnt lgkmcnt(6)
    v_mfma_f32_16x16x32_bf16 v[24:27], v[128:131], v[180:183], v[24:27]
    ds_read_b128 v[192:195], v3 offset:36096
    v_mfma_f32_16x16x32_bf16 v[24:27], v[136:139], v[184:187], v[24:27]
    ds_read_b128 v[168:171], v4 offset:20736
    s_waitcnt lgkmcnt(6)
    v_mfma_f32_16x16x32_bf16 v[24:27], v[144:147], v[188:191], v[24:27]
    ds_read_b128 v[172:175], v252 offset:20736
    s_waitcnt lgkmcnt(6)
    v_mfma_f32_16x16x32_bf16 v[28:31], v[108:111], v[152:155], v[28:31]
    ds_read_b128 v[176:179], v6 offset:20736
    v_mfma_f32_16x16x32_bf16 v[28:31], v[116:119], v[156:159], v[28:31]
    ds_read_b128 v[196:199], v5 offset:20736
    v_mfma_f32_16x16x32_bf16 v[28:31], v[124:127], v[160:163], v[28:31]
    ds_read_b128 v[200:203], v253 offset:20736
    s_waitcnt lgkmcnt(6)
    v_mfma_f32_16x16x32_bf16 v[28:31], v[132:135], v[180:183], v[28:31]
    ds_read_b128 v[204:207], v7 offset:20736
    v_mfma_f32_16x16x32_bf16 v[28:31], v[140:143], v[184:187], v[28:31]
    s_lshl_b32 s39, s37, 6
    v_mfma_f32_16x16x32_bf16 v[28:31], v[148:151], v[188:191], v[28:31]
    s_add_u32 s38, s38, s39
    v_mfma_f32_16x16x32_bf16 v[32:35], v[104:107], v[156:159], v[32:35]
    s_mul_i32 s44, s36, 20
    v_mfma_f32_16x16x32_bf16 v[32:35], v[112:115], v[160:163], v[32:35]
    s_add_u32 s44, s44, s35
    v_mfma_f32_16x16x32_bf16 v[32:35], v[120:123], v[164:167], v[32:35]
    s_mulk_i32 s44, 4608
    v_mfma_f32_16x16x32_bf16 v[32:35], v[128:131], v[184:187], v[32:35]
    s_add_u32 s44, s44, s38
    v_mfma_f32_16x16x32_bf16 v[32:35], v[136:139], v[188:191], v[32:35]
    v_bfe_u32 v15, v1, 3, 2
    s_waitcnt lgkmcnt(0)
    v_mfma_f32_16x16x32_bf16 v[32:35], v[144:147], v[192:195], v[32:35]
    v_and_b32 v228, 3, v1
    v_mfma_f32_16x16x32_bf16 v[36:39], v[108:111], v[156:159], v[36:39]
    v_xor_b32 v15, v15, v228
    v_mfma_f32_16x16x32_bf16 v[36:39], v[116:119], v[160:163], v[36:39]
    v_lshl_add_u32 v15, v15, 4, s44
    v_mfma_f32_16x16x32_bf16 v[36:39], v[124:127], v[164:167], v[36:39]
    v_lshrrev_b32 v228, 2, v1
    v_mfma_f32_16x16x32_bf16 v[36:39], v[132:135], v[184:187], v[36:39]
    v_mul_u32_u24 v11, 1152, v228
    v_mfma_f32_16x16x32_bf16 v[36:39], v[140:143], v[188:191], v[36:39]
    v_lshl_add_u32 v10, v11, 2, v15
    v_mfma_f32_16x16x32_bf16 v[36:39], v[148:151], v[192:195], v[36:39]
    v_add_u32 v11, v11, v15
    v_mfma_f32_16x16x32_bf16 v[40:43], v[104:107], v[160:163], v[40:43]
    v_add_u32 v11, 73728, v11
    v_mfma_f32_16x16x32_bf16 v[40:43], v[112:115], v[164:167], v[40:43]
    s_mov_b32 s46, 0xbfb8aa3b
    v_mfma_f32_16x16x32_bf16 v[40:43], v[128:131], v[188:191], v[40:43]
    s_waitcnt lgkmcnt(0)
    s_barrier
    v_mfma_f32_16x16x32_bf16 v[40:43], v[136:139], v[192:195], v[40:43]
    ds_read_b64_tr_b16 v[64:65], v8 offset:50176
    ds_read_b64_tr_b16 v[66:67], v8 offset:50688
    v_mfma_f32_16x16x32_bf16 v[44:47], v[108:111], v[160:163], v[44:47]
    ds_read_b128 v[152:155], v2 offset:41472
    ds_read_b64_tr_b16 v[72:73], v8 offset:51200
    v_mfma_f32_16x16x32_bf16 v[44:47], v[116:119], v[164:167], v[44:47]
    ds_read_b64_tr_b16 v[74:75], v8 offset:51712
    ds_read_b128 v[156:159], v2 offset:46592
    v_mfma_f32_16x16x32_bf16 v[44:47], v[132:135], v[188:191], v[44:47]
    ds_read_b64_tr_b16 v[88:89], v8 offset:53248
    v_mfma_f32_16x16x32_bf16 v[44:47], v[140:143], v[192:195], v[44:47]
    ds_read_b64_tr_b16 v[90:91], v8 offset:53760
    v_mfma_f32_16x16x32_bf16 v[48:51], v[104:107], v[168:171], v[48:51]
    ds_read_b128 v[180:183], v3 offset:41472
    v_mfma_f32_16x16x32_bf16 v[48:51], v[112:115], v[172:175], v[48:51]
    ds_read_b64_tr_b16 v[96:97], v8 offset:54272
    v_mfma_f32_16x16x32_bf16 v[48:51], v[120:123], v[176:179], v[48:51]
    ds_read_b64_tr_b16 v[98:99], v8 offset:54784
    v_mfma_f32_16x16x32_bf16 v[48:51], v[128:131], v[196:199], v[48:51]
    ds_read_b128 v[184:187], v3 offset:46592
    v_mfma_f32_16x16x32_bf16 v[48:51], v[136:139], v[200:203], v[48:51]
    ds_read_b64_tr_b16 v[68:69], v9 offset:50176
L_pad0:
    s_cbranch_execz L_ret0
    v_mfma_f32_16x16x32_bf16 v[48:51], v[144:147], v[204:207], v[48:51]
    ds_read_b64_tr_b16 v[70:71], v9 offset:50688
    v_mfma_f32_16x16x32_bf16 v[52:55], v[108:111], v[168:171], v[52:55]
    ds_read_b64_tr_b16 v[76:77], v9 offset:51200
    v_mfma_f32_16x16x32_bf16 v[52:55], v[116:119], v[172:175], v[52:55]
    ds_read_b64_tr_b16 v[78:79], v9 offset:51712
    v_mfma_f32_16x16x32_bf16 v[52:55], v[124:127], v[176:179], v[52:55]
    ds_read_b64_tr_b16 v[92:93], v9 offset:53248
    v_mfma_f32_16x16x32_bf16 v[52:55], v[132:135], v[196:199], v[52:55]
    ds_read_b64_tr_b16 v[94:95], v9 offset:53760
    v_mfma_f32_16x16x32_bf16 v[52:55], v[140:143], v[200:203], v[52:55]
    ds_read_b64_tr_b16 v[100:101], v9 offset:54272
    v_mfma_f32_16x16x32_bf16 v[52:55], v[148:151], v[204:207], v[52:55]
    ds_read_b64_tr_b16 v[102:103], v9 offset:54784
    s_waitcnt lgkmcnt(6)
    v_mfma_f32_16x16x32_bf16 v[16:19], v[64:67], v[152:155], v[16:19]
    ds_read_b64_tr_b16 v[56:57], v8 offset:49152
    v_mfma_f32_16x16x32_bf16 v[16:19], v[72:75], v[156:159], v[16:19]
    ds_read_b64_tr_b16 v[58:59], v8 offset:49664
    v_mfma_f32_16x16x32_bf16 v[16:19], v[88:91], v[180:183], v[16:19]
    ds_read_b128 v[160:163], v2 offset:51712
    v_mfma_f32_16x16x32_bf16 v[16:19], v[96:99], v[184:187], v[16:19]
    ds_read_b64_tr_b16 v[80:81], v8 offset:52224
    v_mfma_f32_16x16x32_bf16 v[20:23], v[68:71], v[152:155], v[20:23]
    ds_read_b64_tr_b16 v[82:83], v8 offset:52736
    s_waitcnt lgkmcnt(6)
    v_mfma_f32_16x16x32_bf16 v[20:23], v[76:79], v[156:159], v[20:23]
    ds_read_b128 v[188:191], v3 offset:51712
    v_mfma_f32_16x16x32_bf16 v[20:23], v[92:95], v[180:183], v[20:23]
    ds_read_b64_tr_b16 v[60:61], v9 offset:49152
    s_waitcnt lgkmcnt(6)
    v_mfma_f32_16x16x32_bf16 v[20:23], v[100:103], v[184:187], v[20:23]
    ds_read_b64_tr_b16 v[62:63], v9 offset:49664
    s_waitcnt lgkmcnt(6)
    v_mfma_f32_16x16x32_bf16 v[24:27], v[56:59], v[152:155], v[24:27]
    ds_read_b64_tr_b16 v[84:85], v9 offset:52224
    v_mfma_f32_16x16x32_bf16 v[24:27], v[64:67], v[156:159], v[24:27]
    ds_read_b64_tr_b16 v[86:87], v9 offset:52736
    s_waitcnt lgkmcnt(6)
    v_mfma_f32_16x16x32_bf16 v[24:27], v[72:75], v[160:163], v[24:27]
    ds_read_b128 v[164:167], v2 offset:56832
    s_waitcnt lgkmcnt(6)
    v_mfma_f32_16x16x32_bf16 v[24:27], v[80:83], v[180:183], v[24:27]
    ds_read_b128 v[192:195], v3 offset:56832
    v_mfma_f32_16x16x32_bf16 v[24:27], v[88:91], v[184:187], v[24:27]
    ds_read_b128 v[168:171], v4 offset:41472
    s_waitcnt lgkmcnt(6)
    v_mfma_f32_16x16x32_bf16 v[24:27], v[96:99], v[188:191], v[24:27]
    ds_read_b128 v[172:175], v252 offset:41472
    s_waitcnt lgkmcnt(6)
    v_mfma_f32_16x16x32_bf16 v[28:31], v[60:63], v[152:155], v[28:31]
    ds_read_b128 v[176:179], v6 offset:41472
    v_mfma_f32_16x16x32_bf16 v[28:31], v[68:71], v[156:159], v[28:31]
    ds_read_b128 v[196:199], v5 offset:41472
    v_mfma_f32_16x16x32_bf16 v[28:31], v[76:79], v[160:163], v[28:31]
    ds_read_b128 v[200:203], v253 offset:41472
    s_waitcnt lgkmcnt(6)
    v_mfma_f32_16x16x32_bf16 v[28:31], v[84:87], v[180:183], v[28:31]
    ds_read_b128 v[204:207], v7 offset:41472
    v_mfma_f32_16x16x32_bf16 v[28:31], v[92:95], v[184:187], v[28:31]
    s_mov_b32 s47, 0xbfb8aa3b
    v_mfma_f32_16x16x32_bf16 v[28:31], v[100:103], v[188:191], v[28:31]
    v_mfma_f32_16x16x32_bf16 v[32:35], v[56:59], v[156:159], v[32:35]
    v_mfma_f32_16x16x32_bf16 v[32:35], v[64:67], v[160:163], v[32:35]
    v_mfma_f32_16x16x32_bf16 v[32:35], v[72:75], v[164:167], v[32:35]
    v_mfma_f32_16x16x32_bf16 v[32:35], v[80:83], v[184:187], v[32:35]
    v_mfma_f32_16x16x32_bf16 v[32:35], v[88:91], v[188:191], v[32:35]
    s_waitcnt lgkmcnt(0)
    v_mfma_f32_16x16x32_bf16 v[32:35], v[96:99], v[192:195], v[32:35]
    v_mfma_f32_16x16x32_bf16 v[36:39], v[60:63], v[156:159], v[36:39]
    v_mfma_f32_16x16x32_bf16 v[36:39], v[68:71], v[160:163], v[36:39]
    v_mfma_f32_16x16x32_bf16 v[36:39], v[76:79], v[164:167], v[36:39]
    v_mfma_f32_16x16x32_bf16 v[36:39], v[84:87], v[184:187], v[36:39]
    v_mfma_f32_16x16x32_bf16 v[36:39], v[92:95], v[188:191], v[36:39]
    v_mfma_f32_16x16x32_bf16 v[36:39], v[100:103], v[192:195], v[36:39]
    v_mfma_f32_16x16x32_bf16 v[40:43], v[56:59], v[160:163], v[40:43]
    s_waitcnt lgkmcnt(0)
    s_barrier
    v_mfma_f32_16x16x32_bf16 v[40:43], v[64:67], v[164:167], v[40:43]
    ds_read_b64_tr_b16 v[112:113], v8 offset:1024
    ds_read_b64_tr_b16 v[114:115], v8 offset:1536
    v_mfma_f32_16x16x32_bf16 v[40:43], v[80:83], v[188:191], v[40:43]
    ds_read_b128 v[152:155], v2 offset:0
    v_mfma_f32_16x16x32_bf16 v[40:43], v[88:91], v[192:195], v[40:43]
    ds_read_b64_tr_b16 v[120:121], v8 offset:2048
    v_mfma_f32_16x16x32_bf16 v[44:47], v[60:63], v[160:163], v[44:47]
    ds_read_b64_tr_b16 v[122:123], v8 offset:2560
    v_mfma_f32_16x16x32_bf16 v[44:47], v[68:71], v[164:167], v[44:47]
    ds_read_b128 v[156:159], v2 offset:5120
    v_mfma_f32_16x16x32_bf16 v[44:47], v[84:87], v[188:191], v[44:47]
    ds_read_b64_tr_b16 v[136:137], v8 offset:4096
    v_mfma_f32_16x16x32_bf16 v[44:47], v[92:95], v[192:195], v[44:47]
    ds_read_b64_tr_b16 v[138:139], v8 offset:4608
    v_mfma_f32_16x16x32_bf16 v[48:51], v[56:59], v[168:171], v[48:51]
    ds_read_b128 v[180:183], v3 offset:0
    v_mfma_f32_16x16x32_bf16 v[48:51], v[64:67], v[172:175], v[48:51]
    ds_read_b64_tr_b16 v[144:145], v8 offset:5120
    v_mfma_f32_16x16x32_bf16 v[48:51], v[72:75], v[176:179], v[48:51]
    ds_read_b64_tr_b16 v[146:147], v8 offset:5632
    v_mfma_f32_16x16x32_bf16 v[48:51], v[80:83], v[196:199], v[48:51]
    ds_read_b128 v[184:187], v3 offset:5120
    v_mfma_f32_16x16x32_bf16 v[48:51], v[88:91], v[200:203], v[48:51]
    ds_read_b64_tr_b16 v[116:117], v9 offset:1024
    v_mfma_f32_16x16x32_bf16 v[48:51], v[96:99], v[204:207], v[48:51]
    ds_read_b64_tr_b16 v[118:119], v9 offset:1536
    v_mfma_f32_16x16x32_bf16 v[52:55], v[60:63], v[168:171], v[52:55]
    ds_read_b64_tr_b16 v[124:125], v9 offset:2048
    v_mfma_f32_16x16x32_bf16 v[52:55], v[68:71], v[172:175], v[52:55]
    ds_read_b64_tr_b16 v[126:127], v9 offset:2560
    v_mfma_f32_16x16x32_bf16 v[52:55], v[76:79], v[176:179], v[52:55]
    ds_read_b64_tr_b16 v[140:141], v9 offset:4096
    v_mfma_f32_16x16x32_bf16 v[52:55], v[84:87], v[196:199], v[52:55]
    ds_read_b64_tr_b16 v[142:143], v9 offset:4608
    v_mfma_f32_16x16x32_bf16 v[52:55], v[92:95], v[200:203], v[52:55]
    ds_read_b64_tr_b16 v[148:149], v9 offset:5120
    v_mfma_f32_16x16x32_bf16 v[52:55], v[100:103], v[204:207], v[52:55]
    ds_read_b64_tr_b16 v[150:151], v9 offset:5632
    s_waitcnt lgkmcnt(6)
    v_mfma_f32_16x16x32_bf16 v[16:19], v[112:115], v[152:155], v[16:19]
    ds_read_b64_tr_b16 v[104:105], v8 offset:0
    v_mfma_f32_16x16x32_bf16 v[16:19], v[120:123], v[156:159], v[16:19]
    ds_read_b64_tr_b16 v[106:107], v8 offset:512
    v_mfma_f32_16x16x32_bf16 v[16:19], v[136:139], v[180:183], v[16:19]
    ds_read_b128 v[160:163], v2 offset:10240
    v_mfma_f32_16x16x32_bf16 v[16:19], v[144:147], v[184:187], v[16:19]
    ds_read_b64_tr_b16 v[128:129], v8 offset:3072
    v_mfma_f32_16x16x32_bf16 v[20:23], v[116:119], v[152:155], v[20:23]
    ds_read_b64_tr_b16 v[130:131], v8 offset:3584
    s_waitcnt lgkmcnt(6)
    v_mfma_f32_16x16x32_bf16 v[20:23], v[124:127], v[156:159], v[20:23]
    ds_read_b128 v[188:191], v3 offset:10240
    v_mfma_f32_16x16x32_bf16 v[20:23], v[140:143], v[180:183], v[20:23]
    ds_read_b64_tr_b16 v[108:109], v9 offset:0
    s_waitcnt lgkmcnt(6)
    v_mfma_f32_16x16x32_bf16 v[20:23], v[148:151], v[184:187], v[20:23]
    ds_read_b64_tr_b16 v[110:111], v9 offset:512
    s_waitcnt lgkmcnt(6)
    v_mfma_f32_16x16x32_bf16 v[24:27], v[104:107], v[152:155], v[24:27]
    ds_read_b64_tr_b16 v[132:133], v9 offset:3072
    v_mfma_f32_16x16x32_bf16 v[24:27], v[112:115], v[156:159], v[24:27]
    ds_read_b64_tr_b16 v[134:135], v9 offset:3584
    s_waitcnt lgkmcnt(6)
    v_mfma_f32_16x16x32_bf16 v[24:27], v[120:123], v[160:163], v[24:27]
    ds_read_b128 v[164:167], v2 offset:15360
    s_waitcnt lgkmcnt(6)
    v_mfma_f32_16x16x32_bf16 v[24:27], v[128:131], v[180:183], v[24:27]
    ds_read_b128 v[192:195], v3 offset:15360
    v_mfma_f32_16x16x32_bf16 v[24:27], v[136:139], v[184:187], v[24:27]
    ds_read_b128 v[168:171], v4 offset:0
    s_waitcnt lgkmcnt(6)
    v_mfma_f32_16x16x32_bf16 v[24:27], v[144:147], v[188:191], v[24:27]
    ds_read_b128 v[172:175], v252 offset:0
    s_waitcnt lgkmcnt(6)
    v_mfma_f32_16x16x32_bf16 v[28:31], v[108:111], v[152:155], v[28:31]
    ds_read_b128 v[176:179], v6 offset:0
    v_mfma_f32_16x16x32_bf16 v[28:31], v[116:119], v[156:159], v[28:31]
    ds_read_b128 v[196:199], v5 offset:0
    v_mfma_f32_16x16x32_bf16 v[28:31], v[124:127], v[160:163], v[28:31]
    ds_read_b128 v[200:203], v253 offset:0
    s_waitcnt lgkmcnt(6)
    v_mfma_f32_16x16x32_bf16 v[28:31], v[132:135], v[180:183], v[28:31]
    ds_read_b128 v[204:207], v7 offset:0
    v_mfma_f32_16x16x32_bf16 v[28:31], v[140:143], v[184:187], v[28:31]
    v_mfma_f32_16x16x32_bf16 v[28:31], v[148:151], v[188:191], v[28:31]
    v_mfma_f32_16x16x32_bf16 v[32:35], v[104:107], v[156:159], v[32:35]
    v_mfma_f32_16x16x32_bf16 v[32:35], v[112:115], v[160:163], v[32:35]
    v_mfma_f32_16x16x32_bf16 v[32:35], v[120:123], v[164:167], v[32:35]
    v_mfma_f32_16x16x32_bf16 v[32:35], v[128:131], v[184:187], v[32:35]
    v_mfma_f32_16x16x32_bf16 v[32:35], v[136:139], v[188:191], v[32:35]
    s_waitcnt lgkmcnt(0)
    v_mfma_f32_16x16x32_bf16 v[32:35], v[144:147], v[192:195], v[32:35]
    v_mfma_f32_16x16x32_bf16 v[36:39], v[108:111], v[156:159], v[36:39]
    v_mfma_f32_16x16x32_bf16 v[36:39], v[116:119], v[160:163], v[36:39]
    v_mfma_f32_16x16x32_bf16 v[36:39], v[124:127], v[164:167], v[36:39]
    v_mfma_f32_16x16x32_bf16 v[36:39], v[132:135], v[184:187], v[36:39]
    v_mfma_f32_16x16x32_bf16 v[36:39], v[140:143], v[188:191], v[36:39]
    s_waitcnt lgkmcnt(0)
    s_barrier
    v_mfma_f32_16x16x32_bf16 v[36:39], v[148:151], v[192:195], v[36:39]
    ds_read_b64_tr_b16 v[64:65], v8 offset:25600
    v_mfma_f32_16x16x32_bf16 v[40:43], v[104:107], v[160:163], v[40:43]
    ds_read_b64_tr_b16 v[66:67], v8 offset:26112
    v_mfma_f32_16x16x32_bf16 v[40:43], v[112:115], v[164:167], v[40:43]
    ds_read_b128 v[152:155], v2 offset:20736
    v_mfma_f32_16x16x32_bf16 v[40:43], v[128:131], v[188:191], v[40:43]
    ds_read_b64_tr_b16 v[72:73], v8 offset:26624
    v_mfma_f32_16x16x32_bf16 v[40:43], v[136:139], v[192:195], v[40:43]
    ds_read_b64_tr_b16 v[74:75], v8 offset:27136
    v_mfma_f32_16x16x32_bf16 v[44:47], v[108:111], v[160:163], v[44:47]
    ds_read_b128 v[156:159], v2 offset:25856
    v_mfma_f32_16x16x32_bf16 v[44:47], v[116:119], v[164:167], v[44:47]
    ds_read_b64_tr_b16 v[88:89], v8 offset:28672
    v_mfma_f32_16x16x32_bf16 v[44:47], v[132:135], v[188:191], v[44:47]
    ds_read_b64_tr_b16 v[90:91], v8 offset:29184
    v_mfma_f32_16x16x32_bf16 v[44:47], v[140:143], v[192:195], v[44:47]
    ds_read_b128 v[180:183], v3 offset:20736
    v_mfma_f32_16x16x32_bf16 v[48:51], v[104:107], v[168:171], v[48:51]
    ds_read_b64_tr_b16 v[96:97], v8 offset:29696
    v_mfma_f32_16x16x32_bf16 v[48:51], v[112:115], v[172:175], v[48:51]
    ds_read_b64_tr_b16 v[98:99], v8 offset:30208
    v_mfma_f32_16x16x32_bf16 v[48:51], v[120:123], v[176:179], v[48:51]
    ds_read_b128 v[184:187], v3 offset:25856
    v_mfma_f32_16x16x32_bf16 v[48:51], v[128:131], v[196:199], v[48:51]
    ds_read_b64_tr_b16 v[68:69], v9 offset:25600
    v_mfma_f32_16x16x32_bf16 v[48:51], v[136:139], v[200:203], v[48:51]
    ds_read_b64_tr_b16 v[70:71], v9 offset:26112
    v_mfma_f32_16x16x32_bf16 v[48:51], v[144:147], v[204:207], v[48:51]
    ds_read_b64_tr_b16 v[76:77], v9 offset:26624
    v_mfma_f32_16x16x32_bf16 v[52:55], v[108:111], v[168:171], v[52:55]
    ds_read_b64_tr_b16 v[78:79], v9 offset:27136
    v_mfma_f32_16x16x32_bf16 v[52:55], v[116:119], v[172:175], v[52:55]
    ds_read_b64_tr_b16 v[92:93], v9 offset:28672
    v_mfma_f32_16x16x32_bf16 v[52:55], v[124:127], v[176:179], v[52:55]
    ds_read_b64_tr_b16 v[94:95], v9 offset:29184
    v_mfma_f32_16x16x32_bf16 v[52:55], v[132:135], v[196:199], v[52:55]
    ds_read_b64_tr_b16 v[100:101], v9 offset:29696
    v_mfma_f32_16x16x32_bf16 v[52:55], v[140:143], v[200:203], v[52:55]
    ds_read_b64_tr_b16 v[102:103], v9 offset:30208
    v_mfma_f32_16x16x32_bf16 v[52:55], v[148:151], v[204:207], v[52:55]
    ds_read_b64_tr_b16 v[56:57], v8 offset:24576
    s_waitcnt lgkmcnt(6)
    v_mfma_f32_16x16x32_bf16 v[16:19], v[64:67], v[152:155], v[16:19]
    ds_read_b64_tr_b16 v[58:59], v8 offset:25088
    v_mfma_f32_16x16x32_bf16 v[16:19], v[72:75], v[156:159], v[16:19]
    ds_read_b128 v[160:163], v2 offset:30976
    v_mfma_f32_16x16x32_bf16 v[16:19], v[88:91], v[180:183], v[16:19]
    ds_read_b64_tr_b16 v[80:81], v8 offset:27648
    v_mfma_f32_16x16x32_bf16 v[16:19], v[96:99], v[184:187], v[16:19]
    ds_read_b64_tr_b16 v[82:83], v8 offset:28160
    v_mfma_f32_16x16x32_bf16 v[20:23], v[68:71], v[152:155], v[20:23]
    ds_read_b128 v[188:191], v3 offset:30976
    s_waitcnt lgkmcnt(6)
    v_mfma_f32_16x16x32_bf16 v[20:23], v[76:79], v[156:159], v[20:23]
    ds_read_b64_tr_b16 v[60:61], v9 offset:24576
    v_mfma_f32_16x16x32_bf16 v[20:23], v[92:95], v[180:183], v[20:23]
    ds_read_b64_tr_b16 v[62:63], v9 offset:25088
    v_mfma_f32_16x16x32_bf16 v[20:23], v[100:103], v[184:187], v[20:23]
    ds_read_b64_tr_b16 v[84:85], v9 offset:27648
    s_waitcnt lgkmcnt(6)
    v_mfma_f32_16x16x32_bf16 v[24:27], v[56:59], v[152:155], v[24:27]
    ds_read_b64_tr_b16 v[86:87], v9 offset:28160
    v_mfma_f32_16x16x32_bf16 v[24:27], v[64:67], v[156:159], v[24:27]
    ds_read_b128 v[164:167], v2 offset:36096
    v_mfma_f32_16x16x32_bf16 v[24:27], v[72:75], v[160:163], v[24:27]
    ds_read_b128 v[192:195], v3 offset:36096
    s_waitcnt lgkmcnt(6)
    v_mfma_f32_16x16x32_bf16 v[24:27], v[80:83], v[180:183], v[24:27]
    ds_read_b128 v[168:171], v4 offset:20736
    v_mfma_f32_16x16x32_bf16 v[24:27], v[88:91], v[184:187], v[24:27]
    ds_read_b128 v[172:175], v252 offset:20736
    v_mfma_f32_16x16x32_bf16 v[24:27], v[96:99], v[188:191], v[24:27]
    ds_read_b128 v[176:179], v6 offset:20736
    s_waitcnt lgkmcnt(6)
    v_mfma_f32_16x16x32_bf16 v[28:31], v[60:63], v[152:155], v[28:31]
    ds_read_b128 v[196:199], v5 offset:20736
    v_mfma_f32_16x16x32_bf16 v[28:31], v[68:71], v[156:159], v[28:31]
    ds_read_b128 v[200:203], v253 offset:20736
    v_mfma_f32_16x16x32_bf16 v[28:31], v[76:79], v[160:163], v[28:31]
    ds_read_b128 v[204:207], v7 offset:20736
    s_waitcnt lgkmcnt(6)
    v_mfma_f32_16x16x32_bf16 v[28:31], v[84:87], v[180:183], v[28:31]
    v_mfma_f32_16x16x32_bf16 v[28:31], v[92:95], v[184:187], v[28:31]
    v_mfma_f32_16x16x32_bf16 v[28:31], v[100:103], v[188:191], v[28:31]
    v_mfma_f32_16x16x32_bf16 v[32:35], v[56:59], v[156:159], v[32:35]
    v_mfma_f32_16x16x32_bf16 v[32:35], v[64:67], v[160:163], v[32:35]
    v_mfma_f32_16x16x32_bf16 v[32:35], v[72:75], v[164:167], v[32:35]
    v_mfma_f32_16x16x32_bf16 v[32:35], v[80:83], v[184:187], v[32:35]
    v_mfma_f32_16x16x32_bf16 v[32:35], v[88:91], v[188:191], v[32:35]
    v_mfma_f32_16x16x32_bf16 v[32:35], v[96:99], v[192:195], v[32:35]
    v_mfma_f32_16x16x32_bf16 v[36:39], v[60:63], v[156:159], v[36:39]
    v_mfma_f32_16x16x32_bf16 v[36:39], v[68:71], v[160:163], v[36:39]
    v_mfma_f32_16x16x32_bf16 v[36:39], v[76:79], v[164:167], v[36:39]
    v_mfma_f32_16x16x32_bf16 v[36:39], v[84:87], v[184:187], v[36:39]
    v_mfma_f32_16x16x32_bf16 v[36:39], v[92:95], v[188:191], v[36:39]
    s_waitcnt lgkmcnt(0)
    s_barrier
    v_mfma_f32_16x16x32_bf16 v[36:39], v[100:103], v[192:195], v[36:39]
    ds_read_b64_tr_b16 v[112:113], v8 offset:50176
    v_mfma_f32_16x16x32_bf16 v[40:43], v[56:59], v[160:163], v[40:43]
    ds_read_b64_tr_b16 v[114:115], v8 offset:50688
    v_mfma_f32_16x16x32_bf16 v[40:43], v[64:67], v[164:167], v[40:43]
    ds_read_b128 v[152:155], v2 offset:41472
    v_mfma_f32_16x16x32_bf16 v[40:43], v[80:83], v[188:191], v[40:43]
    ds_read_b64_tr_b16 v[120:121], v8 offset:51200
    v_mfma_f32_16x16x32_bf16 v[40:43], v[88:91], v[192:195], v[40:43]
    ds_read_b64_tr_b16 v[122:123], v8 offset:51712
    v_mfma_f32_16x16x32_bf16 v[44:47], v[60:63], v[160:163], v[44:47]
    ds_read_b128 v[156:159], v2 offset:46592
    v_mfma_f32_16x16x32_bf16 v[44:47], v[68:71], v[164:167], v[44:47]
    ds_read_b64_tr_b16 v[136:137], v8 offset:53248
    v_mfma_f32_16x16x32_bf16 v[44:47], v[84:87], v[188:191], v[44:47]
    ds_read_b64_tr_b16 v[138:139], v8 offset:53760
    v_mfma_f32_16x16x32_bf16 v[44:47], v[92:95], v[192:195], v[44:47]
    ds_read_b128 v[180:183], v3 offset:41472
    v_mfma_f32_16x16x32_bf16 v[48:51], v[56:59], v[168:171], v[48:51]
    ds_read_b64_tr_b16 v[144:145], v8 offset:54272
    v_mfma_f32_16x16x32_bf16 v[48:51], v[64:67], v[172:175], v[48:51]
    ds_read_b64_tr_b16 v[146:147], v8 offset:54784
    v_mfma_f32_16x16x32_bf16 v[48:51], v[72:75], v[176:179], v[48:51]
    ds_read_b128 v[184:187], v3 offset:46592
    v_mfma_f32_16x16x32_bf16 v[48:51], v[80:83], v[196:199], v[48:51]
    ds_read_b64_tr_b16 v[116:117], v9 offset:50176
    v_mfma_f32_16x16x32_bf16 v[48:51], v[88:91], v[200:203], v[48:51]
    ds_read_b64_tr_b16 v[118:119], v9 offset:50688
    v_mfma_f32_16x16x32_bf16 v[48:51], v[96:99], v[204:207], v[48:51]
    ds_read_b64_tr_b16 v[124:125], v9 offset:51200
    v_mfma_f32_16x16x32_bf16 v[52:55], v[60:63], v[168:171], v[52:55]
    ds_read_b64_tr_b16 v[126:127], v9 offset:51712
    v_mfma_f32_16x16x32_bf16 v[52:55], v[68:71], v[172:175], v[52:55]
    ds_read_b64_tr_b16 v[140:141], v9 offset:53248
    v_mfma_f32_16x16x32_bf16 v[52:55], v[76:79], v[176:179], v[52:55]
    ds_read_b64_tr_b16 v[142:143], v9 offset:53760
    v_mfma_f32_16x16x32_bf16 v[52:55], v[84:87], v[196:199], v[52:55]
    ds_read_b64_tr_b16 v[148:149], v9 offset:54272
    v_mfma_f32_16x16x32_bf16 v[52:55], v[92:95], v[200:203], v[52:55]
    ds_read_b64_tr_b16 v[150:151], v9 offset:54784
    v_mfma_f32_16x16x32_bf16 v[52:55], v[100:103], v[204:207], v[52:55]
    ds_read_b64_tr_b16 v[104:105], v8 offset:49152
    s_waitcnt lgkmcnt(6)
    v_mfma_f32_16x16x32_bf16 v[16:19], v[112:115], v[152:155], v[16:19]
    ds_read_b64_tr_b16 v[106:107], v8 offset:49664
    v_mfma_f32_16x16x32_bf16 v[16:19], v[120:123], v[156:159], v[16:19]
    ds_read_b128 v[160:163], v2 offset:51712
    v_mfma_f32_16x16x32_bf16 v[16:19], v[136:139], v[180:183], v[16:19]
    ds_read_b64_tr_b16 v[128:129], v8 offset:52224
    v_mfma_f32_16x16x32_bf16 v[16:19], v[144:147], v[184:187], v[16:19]
    ds_read_b64_tr_b16 v[130:131], v8 offset:52736
    v_mfma_f32_16x16x32_bf16 v[20:23], v[116:119], v[152:155], v[20:23]
    ds_read_b128 v[188:191], v3 offset:51712
    s_waitcnt lgkmcnt(6)
    v_mfma_f32_16x16x32_bf16 v[20:23], v[124:127], v[156:159], v[20:23]
    ds_read_b64_tr_b16 v[108:109], v9 offset:49152
    v_mfma_f32_16x16x32_bf16 v[20:23], v[140:143], v[180:183], v[20:23]
    ds_read_b64_tr_b16 v[110:111], v9 offset:49664
    v_mfma_f32_16x16x32_bf16 v[20:23], v[148:151], v[184:187], v[20:23]
    ds_read_b64_tr_b16 v[132:133], v9 offset:52224
    s_waitcnt lgkmcnt(6)
    v_mfma_f32_16x16x32_bf16 v[24:27], v[104:107], v[152:155], v[24:27]
    ds_read_b64_tr_b16 v[134:135], v9 offset:52736
    v_mfma_f32_16x16x32_bf16 v[24:27], v[112:115], v[156:159], v[24:27]
    ds_read_b128 v[164:167], v2 offset:56832
    v_mfma_f32_16x16x32_bf16 v[24:27], v[120:123], v[160:163], v[24:27]
    ds_read_b128 v[192:195], v3 offset:56832
    s_waitcnt lgkmcnt(6)
    v_mfma_f32_16x16x32_bf16 v[24:27], v[128:131], v[180:183], v[24:27]
    ds_read_b128 v[168:171], v4 offset:41472
    v_mfma_f32_16x16x32_bf16 v[24:27], v[136:139], v[184:187], v[24:27]
    ds_read_b128 v[172:175], v252 offset:41472
    v_mfma_f32_16x16x32_bf16 v[24:27], v[144:147], v[188:191], v[24:27]
    ds_read_b128 v[176:179], v6 offset:41472
    s_waitcnt lgkmcnt(6)
    v_mfma_f32_16x16x32_bf16 v[28:31], v[108:111], v[152:155], v[28:31]
    ds_read_b128 v[196:199], v5 offset:41472
    v_mfma_f32_16x16x32_bf16 v[28:31], v[116:119], v[156:159], v[28:31]
    ds_read_b128 v[200:203], v253 offset:41472
    v_mfma_f32_16x16x32_bf16 v[28:31], v[124:127], v[160:163], v[28:31]
    ds_read_b128 v[204:207], v7 offset:41472
    s_waitcnt lgkmcnt(6)
    v_mfma_f32_16x16x32_bf16 v[28:31], v[132:135], v[180:183], v[28:31]
    v_mfma_f32_16x16x32_bf16 v[28:31], v[140:143], v[184:187], v[28:31]
    v_mfma_f32_16x16x32_bf16 v[28:31], v[148:151], v[188:191], v[28:31]
    v_mfma_f32_16x16x32_bf16 v[32:35], v[104:107], v[156:159], v[32:35]
    v_mfma_f32_16x16x32_bf16 v[32:35], v[112:115], v[160:163], v[32:35]
    v_mfma_f32_16x16x32_bf16 v[32:35], v[120:123], v[164:167], v[32:35]
    v_mfma_f32_16x16x32_bf16 v[32:35], v[128:131], v[184:187], v[32:35]
    v_mfma_f32_16x16x32_bf16 v[32:35], v[136:139], v[188:191], v[32:35]
    v_mfma_f32_16x16x32_bf16 v[32:35], v[144:147], v[192:195], v[32:35]
    v_mfma_f32_16x16x32_bf16 v[36:39], v[108:111], v[156:159], v[36:39]
    v_mfma_f32_16x16x32_bf16 v[36:39], v[116:119], v[160:163], v[36:39]
    v_mfma_f32_16x16x32_bf16 v[36:39], v[124:127], v[164:167], v[36:39]
    v_mfma_f32_16x16x32_bf16 v[36:39], v[132:135], v[184:187], v[36:39]
    v_mfma_f32_16x16x32_bf16 v[36:39], v[140:143], v[188:191], v[36:39]
    s_waitcnt lgkmcnt(0)
    s_barrier
    v_mfma_f32_16x16x32_bf16 v[36:39], v[148:151], v[192:195], v[36:39]
    ds_read_b64_tr_b16 v[64:65], v8 offset:1024
    v_mfma_f32_16x16x32_bf16 v[40:43], v[104:107], v[160:163], v[40:43]
    ds_read_b64_tr_b16 v[66:67], v8 offset:1536
    v_mfma_f32_16x16x32_bf16 v[40:43], v[112:115], v[164:167], v[40:43]
    ds_read_b128 v[152:155], v2 offset:0
    v_mfma_f32_16x16x32_bf16 v[40:43], v[128:131], v[188:191], v[40:43]
    ds_read_b64_tr_b16 v[72:73], v8 offset:2048
    v_mfma_f32_16x16x32_bf16 v[40:43], v[136:139], v[192:195], v[40:43]
    ds_read_b64_tr_b16 v[74:75], v8 offset:2560
    v_mfma_f32_16x16x32_bf16 v[44:47], v[108:111], v[160:163], v[44:47]
    ds_read_b128 v[156:159], v2 offset:5120
    v_mfma_f32_16x16x32_bf16 v[44:47], v[116:119], v[164:167], v[44:47]
    ds_read_b64_tr_b16 v[88:89], v8 offset:4096
    v_mfma_f32_16x16x32_bf16 v[44:47], v[132:135], v[188:191], v[44:47]
    ds_read_b64_tr_b16 v[90:91], v8 offset:4608
    v_mfma_f32_16x16x32_bf16 v[44:47], v[140:143], v[192:195], v[44:47]
    ds_read_b128 v[180:183], v3 offset:0
    v_mfma_f32_16x16x32_bf16 v[48:51], v[104:107], v[168:171], v[48:51]
    ds_read_b64_tr_b16 v[96:97], v8 offset:5120
    v_mfma_f32_16x16x32_bf16 v[48:51], v[112:115], v[172:175], v[48:51]
    ds_read_b64_tr_b16 v[98:99], v8 offset:5632
    v_mfma_f32_16x16x32_bf16 v[48:51], v[120:123], v[176:179], v[48:51]
    ds_read_b128 v[184:187], v3 offset:5120
    v_mfma_f32_16x16x32_bf16 v[48:51], v[128:131], v[196:199], v[48:51]
    ds_read_b64_tr_b16 v[68:69], v9 offset:1024
    v_mfma_f32_16x16x32_bf16 v[48:51], v[136:139], v[200:203], v[48:51]
    ds_read_b64_tr_b16 v[70:71], v9 offset:1536
    v_mfma_f32_16x16x32_bf16 v[48:51], v[144:147], v[204:207], v[48:51]
    ds_read_b64_tr_b16 v[76:77], v9 offset:2048
    v_mfma_f32_16x16x32_bf16 v[52:55], v[108:111], v[168:171], v[52:55]
    ds_read_b64_tr_b16 v[78:79], v9 offset:2560
    v_mfma_f32_16x16x32_bf16 v[52:55], v[116:119], v[172:175], v[52:55]
    ds_read_b64_tr_b16 v[92:93], v9 offset:4096
    v_mfma_f32_16x16x32_bf16 v[52:55], v[124:127], v[176:179], v[52:55]
    ds_read_b64_tr_b16 v[94:95], v9 offset:4608
    v_mfma_f32_16x16x32_bf16 v[52:55], v[132:135], v[196:199], v[52:55]
    ds_read_b64_tr_b16 v[100:101], v9 offset:5120
    v_mfma_f32_16x16x32_bf16 v[52:55], v[140:143], v[200:203], v[52:55]
    ds_read_b64_tr_b16 v[102:103], v9 offset:5632
    v_mfma_f32_16x16x32_bf16 v[52:55], v[148:151], v[204:207], v[52:55]
    ds_read_b64_tr_b16 v[56:57], v8 offset:0
    s_waitcnt lgkmcnt(6)
    v_mfma_f32_16x16x32_bf16 v[16:19], v[64:67], v[152:155], v[16:19]
    ds_read_b64_tr_b16 v[58:59], v8 offset:512
    v_mfma_f32_16x16x32_bf16 v[16:19], v[72:75], v[156:159], v[16:19]
    ds_read_b128 v[160:163], v2 offset:10240
    v_mfma_f32_16x16x32_bf16 v[16:19], v[88:91], v[180:183], v[16:19]
    ds_read_b64_tr_b16 v[80:81], v8 offset:3072
    v_mfma_f32_16x16x32_bf16 v[16:19], v[96:99], v[184:187], v[16:19]
    ds_read_b64_tr_b16 v[82:83], v8 offset:3584
    v_mfma_f32_16x16x32_bf16 v[20:23], v[68:71], v[152:155], v[20:23]
    ds_read_b128 v[188:191], v3 offset:10240
    s_waitcnt lgkmcnt(6)
    v_mfma_f32_16x16x32_bf16 v[20:23], v[76:79], v[156:159], v[20:23]
    ds_read_b64_tr_b16 v[60:61], v9 offset:0
    v_mfma_f32_16x16x32_bf16 v[20:23], v[92:95], v[180:183], v[20:23]
    ds_read_b64_tr_b16 v[62:63], v9 offset:512
    v_mfma_f32_16x16x32_bf16 v[20:23], v[100:103], v[184:187], v[20:23]
    ds_read_b64_tr_b16 v[84:85], v9 offset:3072
    s_waitcnt lgkmcnt(6)
    v_mfma_f32_16x16x32_bf16 v[24:27], v[56:59], v[152:155], v[24:27]
    ds_read_b64_tr_b16 v[86:87], v9 offset:3584
    v_mfma_f32_16x16x32_bf16 v[24:27], v[64:67], v[156:159], v[24:27]
    ds_read_b128 v[164:167], v2 offset:15360
    v_mfma_f32_16x16x32_bf16 v[24:27], v[72:75], v[160:163], v[24:27]
    ds_read_b128 v[192:195], v3 offset:15360
    s_waitcnt lgkmcnt(6)
    v_mfma_f32_16x16x32_bf16 v[24:27], v[80:83], v[180:183], v[24:27]
    ds_read_b128 v[168:171], v4 offset:0
    v_mfma_f32_16x16x32_bf16 v[24:27], v[88:91], v[184:187], v[24:27]
    ds_read_b128 v[172:175], v252 offset:0
    v_mfma_f32_16x16x32_bf16 v[24:27], v[96:99], v[188:191], v[24:27]
    ds_read_b128 v[176:179], v6 offset:0
    s_waitcnt lgkmcnt(6)
    v_mfma_f32_16x16x32_bf16 v[28:31], v[60:63], v[152:155], v[28:31]
    ds_read_b128 v[196:199], v5 offset:0
    v_mfma_f32_16x16x32_bf16 v[28:31], v[68:71], v[156:159], v[28:31]
    ds_read_b128 v[200:203], v253 offset:0
    v_mfma_f32_16x16x32_bf16 v[28:31], v[76:79], v[160:163], v[28:31]
    ds_read_b128 v[204:207], v7 offset:0
    s_waitcnt lgkmcnt(6)
    v_mfma_f32_16x16x32_bf16 v[28:31], v[84:87], v[180:183], v[28:31]
    v_mfma_f32_16x16x32_bf16 v[28:31], v[92:95], v[184:187], v[28:31]
    v_mfma_f32_16x16x32_bf16 v[28:31], v[100:103], v[188:191], v[28:31]
    v_mfma_f32_16x16x32_bf16 v[32:35], v[56:59], v[156:159], v[32:35]
    v_mfma_f32_16x16x32_bf16 v[32:35], v[64:67], v[160:163], v[32:35]
    v_mfma_f32_16x16x32_bf16 v[32:35], v[72:75], v[164:167], v[32:35]
    v_mfma_f32_16x16x32_bf16 v[32:35], v[80:83], v[184:187], v[32:35]
    v_mfma_f32_16x16x32_bf16 v[32:35], v[88:91], v[188:191], v[32:35]
    v_mfma_f32_16x16x32_bf16 v[32:35], v[96:99], v[192:195], v[32:35]
    v_mfma_f32_16x16x32_bf16 v[36:39], v[60:63], v[156:159], v[36:39]
    v_mfma_f32_16x16x32_bf16 v[36:39], v[68:71], v[160:163], v[36:39]
    v_mfma_f32_16x16x32_bf16 v[36:39], v[76:79], v[164:167], v[36:39]
    v_mfma_f32_16x16x32_bf16 v[36:39], v[84:87], v[184:187], v[36:39]
    v_mfma_f32_16x16x32_bf16 v[36:39], v[92:95], v[188:191], v[36:39]
    s_waitcnt lgkmcnt(0)
    s_barrier
    v_mfma_f32_16x16x32_bf16 v[36:39], v[100:103], v[192:195], v[36:39]
    ds_read_b64_tr_b16 v[112:113], v8 offset:25600
    v_mfma_f32_16x16x32_bf16 v[40:43], v[56:59], v[160:163], v[40:43]
    ds_read_b64_tr_b16 v[114:115], v8 offset:26112
    v_mfma_f32_16x16x32_bf16 v[40:43], v[64:67], v[164:167], v[40:43]
    ds_read_b128 v[152:155], v2 offset:20736
    v_mfma_f32_16x16x32_bf16 v[40:43], v[80:83], v[188:191], v[40:43]
    ds_read_b64_tr_b16 v[120:121], v8 offset:26624
    v_mfma_f32_16x16x32_bf16 v[40:43], v[88:91], v[192:195], v[40:43]
    ds_read_b64_tr_b16 v[122:123], v8 offset:27136
    v_mfma_f32_16x16x32_bf16 v[44:47], v[60:63], v[160:163], v[44:47]
    ds_read_b128 v[156:159], v2 offset:25856
    v_mfma_f32_16x16x32_bf16 v[44:47], v[68:71], v[164:167], v[44:47]
    ds_read_b64_tr_b16 v[136:137], v8 offset:28672
    v_mfma_f32_16x16x32_bf16 v[44:47], v[84:87], v[188:191], v[44:47]
    ds_read_b64_tr_b16 v[138:139], v8 offset:29184
    v_mfma_f32_16x16x32_bf16 v[44:47], v[92:95], v[192:195], v[44:47]
    ds_read_b128 v[180:183], v3 offset:20736
    v_mfma_f32_16x16x32_bf16 v[48:51], v[56:59], v[168:171], v[48:51]
    ds_read_b64_tr_b16 v[144:145], v8 offset:29696
    v_mfma_f32_16x16x32_bf16 v[48:51], v[64:67], v[172:175], v[48:51]
    ds_read_b64_tr_b16 v[146:147], v8 offset:30208
    v_mfma_f32_16x16x32_bf16 v[48:51], v[72:75], v[176:179], v[48:51]
    ds_read_b128 v[184:187], v3 offset:25856
    v_mfma_f32_16x16x32_bf16 v[48:51], v[80:83], v[196:199], v[48:51]
    ds_read_b64_tr_b16 v[116:117], v9 offset:25600
    v_mfma_f32_16x16x32_bf16 v[48:51], v[88:91], v[200:203], v[48:51]
    ds_read_b64_tr_b16 v[118:119], v9 offset:26112
    v_mfma_f32_16x16x32_bf16 v[48:51], v[96:99], v[204:207], v[48:51]
    ds_read_b64_tr_b16 v[124:125], v9 offset:26624
    v_mfma_f32_16x16x32_bf16 v[52:55], v[60:63], v[168:171], v[52:55]
    ds_read_b64_tr_b16 v[126:127], v9 offset:27136
    v_mfma_f32_16x16x32_bf16 v[52:55], v[68:71], v[172:175], v[52:55]
    ds_read_b64_tr_b16 v[140:141], v9 offset:28672
    v_mfma_f32_16x16x32_bf16 v[52:55], v[76:79], v[176:179], v[52:55]
    ds_read_b64_tr_b16 v[142:143], v9 offset:29184
    v_mfma_f32_16x16x32_bf16 v[52:55], v[84:87], v[196:199], v[52:55]
    ds_read_b64_tr_b16 v[148:149], v9 offset:29696
    v_mfma_f32_16x16x32_bf16 v[52:55], v[92:95], v[200:203], v[52:55]
    ds_read_b64_tr_b16 v[150:151], v9 offset:30208
    v_mfma_f32_16x16x32_bf16 v[52:55], v[100:103], v[204:207], v[52:55]
    ds_read_b64_tr_b16 v[104:105], v8 offset:24576
    s_waitcnt lgkmcnt(6)
    v_mfma_f32_16x16x32_bf16 v[16:19], v[112:115], v[152:155], v[16:19]
    ds_read_b64_tr_b16 v[106:107], v8 offset:25088
    v_mfma_f32_16x16x32_bf16 v[16:19], v[120:123], v[156:159], v[16:19]
    ds_read_b128 v[160:163], v2 offset:30976
    v_mfma_f32_16x16x32_bf16 v[16:19], v[136:139], v[180:183], v[16:19]
    ds_read_b64_tr_b16 v[128:129], v8 offset:27648
    v_mfma_f32_16x16x32_bf16 v[16:19], v[144:147], v[184:187], v[16:19]
    ds_read_b64_tr_b16 v[130:131], v8 offset:28160
    v_mfma_f32_16x16x32_bf16 v[20:23], v[116:119], v[152:155], v[20:23]
    ds_read_b128 v[188:191], v3 offset:30976
    s_waitcnt lgkmcnt(6)
    v_mfma_f32_16x16x32_bf16 v[20:23], v[124:127], v[156:159], v[20:23]
    ds_read_b64_tr_b16 v[108:109], v9 offset:24576
    v_mfma_f32_16x16x32_bf16 v[20:23], v[140:143], v[180:183], v[20:23]
    ds_read_b64_tr_b16 v[110:111], v9 offset:25088
    v_mfma_f32_16x16x32_bf16 v[20:23], v[148:151], v[184:187], v[20:23]
    ds_read_b64_tr_b16 v[132:133], v9 offset:27648
    s_waitcnt lgkmcnt(6)
    v_mfma_f32_16x16x32_bf16 v[24:27], v[104:107], v[152:155], v[24:27]
    ds_read_b64_tr_b16 v[134:135], v9 offset:28160
    v_mfma_f32_16x16x32_bf16 v[24:27], v[112:115], v[156:159], v[24:27]
    ds_read_b128 v[164:167], v2 offset:36096
L_pad1:
    s_cbranch_execz L_ret1
    v_mfma_f32_16x16x32_bf16 v[24:27], v[120:123], v[160:163], v[24:27]
    ds_read_b128 v[192:195], v3 offset:36096
    s_waitcnt lgkmcnt(6)
    v_mfma_f32_16x16x32_bf16 v[24:27], v[128:131], v[180:183], v[24:27]
    ds_read_b128 v[168:171], v4 offset:20736
    v_mfma_f32_16x16x32_bf16 v[24:27], v[136:139], v[184:187], v[24:27]
    ds_read_b128 v[172:175], v252 offset:20736
    v_mfma_f32_16x16x32_bf16 v[24:27], v[144:147], v[188:191], v[24:27]
    ds_read_b128 v[176:179], v6 offset:20736
    s_waitcnt lgkmcnt(6)
    v_mfma_f32_16x16x32_bf16 v[28:31], v[108:111], v[152:155], v[28:31]
    ds_read_b128 v[196:199], v5 offset:20736
    v_mfma_f32_16x16x32_bf16 v[28:31], v[116:119], v[156:159], v[28:31]
    ds_read_b128 v[200:203], v253 offset:20736
    v_mfma_f32_16x16x32_bf16 v[28:31], v[124:127], v[160:163], v[28:31]
    ds_read_b128 v[204:207], v7 offset:20736
    s_waitcnt lgkmcnt(6)
    v_mfma_f32_16x16x32_bf16 v[28:31], v[132:135], v[180:183], v[28:31]
    v_mfma_f32_16x16x32_bf16 v[28:31], v[140:143], v[184:187], v[28:31]
    v_mfma_f32_16x16x32_bf16 v[28:31], v[148:151], v[188:191], v[28:31]
    v_mfma_f32_16x16x32_bf16 v[32:35], v[104:107], v[156:159], v[32:35]
    v_mfma_f32_16x16x32_bf16 v[32:35], v[112:115], v[160:163], v[32:35]
    v_mfma_f32_16x16x32_bf16 v[32:35], v[120:123], v[164:167], v[32:35]
    s_waitcnt lgkmcnt(0)
    s_barrier
    v_mfma_f32_16x16x32_bf16 v[32:35], v[128:131], v[184:187], v[32:35]
    ds_read_b64_tr_b16 v[64:65], v8 offset:50176
    ds_read_b64_tr_b16 v[66:67], v8 offset:50688
    v_mfma_f32_16x16x32_bf16 v[32:35], v[136:139], v[188:191], v[32:35]
    ds_read_b128 v[152:155], v2 offset:41472
    ds_read_b64_tr_b16 v[72:73], v8 offset:51200
    v_mfma_f32_16x16x32_bf16 v[32:35], v[144:147], v[192:195], v[32:35]
    ds_read_b64_tr_b16 v[74:75], v8 offset:51712
    ds_read_b64_tr_b16 v[88:89], v8 offset:53248
    v_mfma_f32_16x16x32_bf16 v[36:39], v[108:111], v[156:159], v[36:39]
    ds_read_b64_tr_b16 v[90:91], v8 offset:53760
    ds_read_b128 v[180:183], v3 offset:41472
    v_mfma_f32_16x16x32_bf16 v[36:39], v[116:119], v[160:163], v[36:39]
    ds_read_b128 v[156:159], v2 offset:46592
    ds_read_b64_tr_b16 v[96:97], v8 offset:54272
    v_mfma_f32_16x16x32_bf16 v[36:39], v[124:127], v[164:167], v[36:39]
    ds_read_b64_tr_b16 v[98:99], v8 offset:54784
    ds_read_b64_tr_b16 v[68:69], v9 offset:50176
    v_mfma_f32_16x16x32_bf16 v[36:39], v[132:135], v[184:187], v[36:39]
    ds_read_b64_tr_b16 v[70:71], v9 offset:50688
    ds_read_b64_tr_b16 v[76:77], v9 offset:51200
    v_mfma_f32_16x16x32_bf16 v[36:39], v[140:143], v[188:191], v[36:39]
    ds_read_b128 v[184:187], v3 offset:46592
    ds_read_b64_tr_b16 v[78:79], v9 offset:51712
    v_mfma_f32_16x16x32_bf16 v[36:39], v[148:151], v[192:195], v[36:39]
    ds_read_b64_tr_b16 v[92:93], v9 offset:53248
    ds_read_b64_tr_b16 v[94:95], v9 offset:53760
    v_mfma_f32_16x16x32_bf16 v[40:43], v[104:107], v[160:163], v[40:43]
    ds_read_b64_tr_b16 v[100:101], v9 offset:54272
    ds_read_b64_tr_b16 v[102:103], v9 offset:54784
    v_mfma_f32_16x16x32_bf16 v[40:43], v[112:115], v[164:167], v[40:43]
    ds_read_b64_tr_b16 v[56:57], v8 offset:49152
    ds_read_b64_tr_b16 v[58:59], v8 offset:49664
    v_mfma_f32_16x16x32_bf16 v[40:43], v[128:131], v[188:191], v[40:43]
    ds_read_b64_tr_b16 v[80:81], v8 offset:52224
    v_mfma_f32_16x16x32_bf16 v[40:43], v[136:139], v[192:195], v[40:43]
    ds_read_b64_tr_b16 v[82:83], v8 offset:52736
    v_mfma_f32_16x16x32_bf16 v[44:47], v[108:111], v[160:163], v[44:47]
    ds_read_b128 v[212:215], v12
    v_mfma_f32_16x16x32_bf16 v[44:47], v[116:119], v[164:167], v[44:47]
    ds_read_b128 v[160:163], v2 offset:51712
    v_mfma_f32_16x16x32_bf16 v[44:47], v[132:135], v[188:191], v[44:47]
    ds_read_b128 v[164:167], v2 offset:56832
    v_mfma_f32_16x16x32_bf16 v[44:47], v[140:143], v[192:195], v[44:47]
    ds_read_b128 v[188:191], v3 offset:51712
    s_waitcnt lgkmcnt(6)
    v_mfma_f32_16x16x32_bf16 v[16:19], v[64:67], v[152:155], v[16:19]
    ds_read_b128 v[216:219], v12 offset:64
    v_mfma_f32_16x16x32_bf16 v[16:19], v[72:75], v[156:159], v[16:19]
    ds_read_b128 v[220:223], v12 offset:256
    v_mfma_f32_16x16x32_bf16 v[16:19], v[88:91], v[180:183], v[16:19]
    ds_read_b128 v[224:227], v12 offset:320
    v_mfma_f32_16x16x32_bf16 v[16:19], v[96:99], v[184:187], v[16:19]
    ds_read_b128 v[192:195], v3 offset:56832
    v_mfma_f32_16x16x32_bf16 v[20:23], v[68:71], v[152:155], v[20:23]
    ds_read_b64_tr_b16 v[60:61], v9 offset:49152
    v_mfma_f32_16x16x32_bf16 v[20:23], v[76:79], v[156:159], v[20:23]
    ds_read_b64_tr_b16 v[62:63], v9 offset:49664
    v_mfma_f32_16x16x32_bf16 v[20:23], v[92:95], v[180:183], v[20:23]
    ds_read_b64_tr_b16 v[84:85], v9 offset:52224
    v_mfma_f32_16x16x32_bf16 v[20:23], v[100:103], v[184:187], v[20:23]
    ds_read_b64_tr_b16 v[86:87], v9 offset:52736
    s_waitcnt lgkmcnt(6)
    v_mfma_f32_16x16x32_bf16 v[40:43], v[56:59], v[160:163], v[40:43]
    v_mfma_f32_16x16x32_bf16 v[40:43], v[64:67], v[164:167], v[40:43]
    v_mfma_f32_16x16x32_bf16 v[40:43], v[80:83], v[188:191], v[40:43]
    s_waitcnt lgkmcnt(3)
    v_fma_f32 v16, v16, v212, v220
    v_fma_f32 v17, v17, v213, v221
    v_mfma_f32_16x16x32_bf16 v[40:43], v[88:91], v[192:195], v[40:43]
    v_fma_f32 v18, v18, v214, v222
    v_fma_f32 v19, v19, v215, v223
    s_waitcnt lgkmcnt(2)
    v_mfma_f32_16x16x32_bf16 v[44:47], v[60:63], v[160:163], v[44:47]
    v_fma_f32 v20, v20, v216, v224
    v_fma_f32 v21, v21, v217, v225
    v_mfma_f32_16x16x32_bf16 v[44:47], v[68:71], v[164:167], v[44:47]
    v_fma_f32 v22, v22, v218, v226
    v_fma_f32 v23, v23, v219, v227
    s_waitcnt lgkmcnt(0)
    v_mfma_f32_16x16x32_bf16 v[44:47], v[84:87], v[188:191], v[44:47]
    v_exp_f32 v228, v16
    v_mfma_f32_16x16x32_bf16 v[44:47], v[92:95], v[192:195], v[44:47]
    v_exp_f32 v229, v17
    v_mfma_f32_16x16x32_bf16 v[24:27], v[56:59], v[152:155], v[24:27]
    v_exp_f32 v230, v18
    v_mfma_f32_16x16x32_bf16 v[24:27], v[64:67], v[156:159], v[24:27]
    v_exp_f32 v231, v19
    v_mfma_f32_16x16x32_bf16 v[24:27], v[72:75], v[160:163], v[24:27]
    v_exp_f32 v232, v20
    v_mfma_f32_16x16x32_bf16 v[24:27], v[80:83], v[180:183], v[24:27]
    v_exp_f32 v233, v21
    v_mfma_f32_16x16x32_bf16 v[24:27], v[88:91], v[184:187], v[24:27]
    v_exp_f32 v234, v22
    v_mfma_f32_16x16x32_bf16 v[24:27], v[96:99], v[188:191], v[24:27]
    v_exp_f32 v235, v23
    v_mfma_f32_16x16x32_bf16 v[28:31], v[60:63], v[152:155], v[28:31]
    v_fma_f32 v228, v228, s46, s46
    v_fma_f32 v229, v229, s46, s46
    v_mfma_f32_16x16x32_bf16 v[28:31], v[68:71], v[156:159], v[28:31]
    v_fma_f32 v230, v230, s46, s46
    v_fma_f32 v231, v231, s46, s46
    v_mfma_f32_16x16x32_bf16 v[28:31], v[76:79], v[160:163], v[28:31]
    v_fma_f32 v232, v232, s46, s46
    v_fma_f32 v233, v233, s46, s46
    v_mfma_f32_16x16x32_bf16 v[28:31], v[84:87], v[180:183], v[28:31]
    v_fma_f32 v234, v234, s46, s46
    v_fma_f32 v235, v235, s46, s46
    v_mfma_f32_16x16x32_bf16 v[28:31], v[92:95], v[184:187], v[28:31]
    v_rcp_f32 v228, v228
    v_mfma_f32_16x16x32_bf16 v[28:31], v[100:103], v[188:191], v[28:31]
    v_rcp_f32 v229, v229
    v_mfma_f32_16x16x32_bf16 v[48:51], v[104:107], v[168:171], v[48:51]
    v_rcp_f32 v230, v230
    v_mfma_f32_16x16x32_bf16 v[48:51], v[112:115], v[172:175], v[48:51]
    v_rcp_f32 v231, v231
    v_mfma_f32_16x16x32_bf16 v[48:51], v[120:123], v[176:179], v[48:51]
    v_rcp_f32 v232, v232
    v_mfma_f32_16x16x32_bf16 v[48:51], v[128:131], v[196:199], v[48:51]
    v_rcp_f32 v233, v233
    v_mfma_f32_16x16x32_bf16 v[48:51], v[136:139], v[200:203], v[48:51]
    v_rcp_f32 v234, v234
    v_mfma_f32_16x16x32_bf16 v[48:51], v[144:147], v[204:207], v[48:51]
    v_rcp_f32 v235, v235
    v_mfma_f32_16x16x32_bf16 v[52:55], v[108:111], v[168:171], v[52:55]
    v_mul_f32 v16, v16, v228
    v_mul_f32 v17, v17, v229
    v_mfma_f32_16x16x32_bf16 v[52:55], v[116:119], v[172:175], v[52:55]
    ds_read_b128 v[168:171], v4 offset:41472
    v_mul_f32 v18, v18, v230
    v_mul_f32 v19, v19, v231
    v_mfma_f32_16x16x32_bf16 v[52:55], v[124:127], v[176:179], v[52:55]
    ds_read_b128 v[172:175], v252 offset:41472
    v_mul_f32 v20, v20, v232
    v_mul_f32 v21, v21, v233
    v_mfma_f32_16x16x32_bf16 v[52:55], v[132:135], v[196:199], v[52:55]
    ds_read_b128 v[176:179], v6 offset:41472
    v_mul_f32 v22, v22, v234
    v_mul_f32 v23, v23, v235
    v_mfma_f32_16x16x32_bf16 v[52:55], v[140:143], v[200:203], v[52:55]
    ds_read_b128 v[196:199], v5 offset:41472
    v_cvt_pk_bf16_f32 v236, v16, v17
    v_cvt_pk_bf16_f32 v237, v18, v19
    v_mfma_f32_16x16x32_bf16 v[52:55], v[148:151], v[204:207], v[52:55]
    ds_read_b128 v[200:203], v253 offset:41472
    v_cvt_pk_bf16_f32 v238, v20, v21
    ds_write_b64 v250, v[236:237]
    v_mfma_f32_16x16x32_bf16 v[32:35], v[56:59], v[156:159], v[32:35]
    ds_read_b128 v[204:207], v7 offset:41472
    v_cvt_pk_bf16_f32 v239, v22, v23
    ds_write_b64 v254, v[238:239]
    v_mfma_f32_16x16x32_bf16 v[32:35], v[64:67], v[160:163], v[32:35]
    ds_read_b128 v[240:243], v251
    v_fma_f32 v40, v40, v212, v220
    v_mfma_f32_16x16x32_bf16 v[32:35], v[72:75], v[164:167], v[32:35]
    v_fma_f32 v41, v41, v213, v221
    v_fma_f32 v42, v42, v214, v222
    v_mfma_f32_16x16x32_bf16 v[32:35], v[80:83], v[184:187], v[32:35]
    v_fma_f32 v43, v43, v215, v223
    v_fma_f32 v44, v44, v216, v224
    v_mfma_f32_16x16x32_bf16 v[32:35], v[88:91], v[188:191], v[32:35]
    v_fma_f32 v45, v45, v217, v225
    v_fma_f32 v46, v46, v218, v226
    v_mfma_f32_16x16x32_bf16 v[32:35], v[96:99], v[192:195], v[32:35]
    v_fma_f32 v47, v47, v219, v227
    v_exp_f32 v228, v40
    v_mfma_f32_16x16x32_bf16 v[36:39], v[60:63], v[156:159], v[36:39]
    v_exp_f32 v229, v41
    v_mfma_f32_16x16x32_bf16 v[36:39], v[68:71], v[160:163], v[36:39]
    v_exp_f32 v230, v42
    v_mfma_f32_16x16x32_bf16 v[36:39], v[76:79], v[164:167], v[36:39]
    v_exp_f32 v231, v43
    v_mfma_f32_16x16x32_bf16 v[36:39], v[84:87], v[184:187], v[36:39]
    v_exp_f32 v232, v44
    v_mfma_f32_16x16x32_bf16 v[36:39], v[92:95], v[188:191], v[36:39]
    v_exp_f32 v233, v45
    v_mfma_f32_16x16x32_bf16 v[36:39], v[100:103], v[192:195], v[36:39]
    v_exp_f32 v234, v46
    s_waitcnt lgkmcnt(0)
    v_mfma_f32_16x16x32_bf16 v[48:51], v[56:59], v[168:171], v[48:51]
    v_exp_f32 v235, v47
    v_mfma_f32_16x16x32_bf16 v[48:51], v[64:67], v[172:175], v[48:51]
    v_fma_f32 v228, v228, s46, s46
    v_fma_f32 v229, v229, s46, s46
    v_mfma_f32_16x16x32_bf16 v[48:51], v[72:75], v[176:179], v[48:51]
    s_waitcnt lgkmcnt(0)
    buffer_store_dwordx4 v[240:243], v10, s[28:31], 0 offen offset:0 sc1
    v_fma_f32 v230, v230, s46, s46
    v_fma_f32 v231, v231, s46, s46
    v_mfma_f32_16x16x32_bf16 v[48:51], v[80:83], v[196:199], v[48:51]
    v_fma_f32 v232, v232, s46, s46
    v_fma_f32 v233, v233, s46, s46
    v_mfma_f32_16x16x32_bf16 v[48:51], v[88:91], v[200:203], v[48:51]
    v_fma_f32 v234, v234, s46, s46
    v_fma_f32 v235, v235, s46, s46
    v_mfma_f32_16x16x32_bf16 v[48:51], v[96:99], v[204:207], v[48:51]
    v_rcp_f32 v228, v228
    v_mfma_f32_16x16x32_bf16 v[52:55], v[60:63], v[168:171], v[52:55]
    v_rcp_f32 v229, v229
    v_mfma_f32_16x16x32_bf16 v[52:55], v[68:71], v[172:175], v[52:55]
    v_rcp_f32 v230, v230
    v_mfma_f32_16x16x32_bf16 v[52:55], v[76:79], v[176:179], v[52:55]
    v_rcp_f32 v231, v231
    v_mfma_f32_16x16x32_bf16 v[52:55], v[84:87], v[196:199], v[52:55]
    v_rcp_f32 v232, v232
    v_mfma_f32_16x16x32_bf16 v[52:55], v[92:95], v[200:203], v[52:55]
    v_rcp_f32 v233, v233
    v_mfma_f32_16x16x32_bf16 v[52:55], v[100:103], v[204:207], v[52:55]
    v_rcp_f32 v234, v234
    v_rcp_f32 v235, v235
    v_pk_mul_f32 v[40:41], v[40:41], v[228:229]
    v_pk_mul_f32 v[42:43], v[42:43], v[230:231]
    v_pk_mul_f32 v[44:45], v[44:45], v[232:233]
    v_pk_mul_f32 v[46:47], v[46:47], v[234:235]
    v_cvt_pk_bf16_f32 v236, v40, v41
    v_cvt_pk_bf16_f32 v237, v42, v43
    v_cvt_pk_bf16_f32 v238, v44, v45
    ds_write_b64 v250, v[236:237]
    v_cvt_pk_bf16_f32 v239, v46, v47
    ds_write_b64 v254, v[238:239]
    ds_read_b128 v[244:247], v251
    v_pk_fma_f32 v[24:25], v[24:25], v[212:213], v[220:221]
    v_pk_fma_f32 v[26:27], v[26:27], v[214:215], v[222:223]
    v_pk_fma_f32 v[28:29], v[28:29], v[216:217], v[224:225]
    v_pk_fma_f32 v[30:31], v[30:31], v[218:219], v[226:227]
    v_exp_f32 v228, v24
    v_exp_f32 v229, v25
    v_exp_f32 v230, v26
    v_exp_f32 v231, v27
    v_exp_f32 v232, v28
    v_exp_f32 v233, v29
    v_exp_f32 v234, v30
    v_exp_f32 v235, v31
    v_pk_fma_f32 v[228:229], v[228:229], s[46:47], s[46:47]
    s_waitcnt lgkmcnt(0)
    buffer_store_dwordx4 v[244:247], v10, s[28:31], 0 offen offset:3456 sc1
    v_pk_fma_f32 v[230:231], v[230:231], s[46:47], s[46:47]
    v_pk_fma_f32 v[232:233], v[232:233], s[46:47], s[46:47]
    v_pk_fma_f32 v[234:235], v[234:235], s[46:47], s[46:47]
    v_rcp_f32 v228, v228
    v_rcp_f32 v229, v229
    v_rcp_f32 v230, v230
    v_rcp_f32 v231, v231
    v_rcp_f32 v232, v232
    v_rcp_f32 v233, v233
    v_rcp_f32 v234, v234
    v_rcp_f32 v235, v235
    v_pk_mul_f32 v[24:25], v[24:25], v[228:229]
    v_pk_mul_f32 v[26:27], v[26:27], v[230:231]
    v_pk_mul_f32 v[28:29], v[28:29], v[232:233]
    v_pk_mul_f32 v[30:31], v[30:31], v[234:235]
    v_cvt_pk_bf16_f32 v236, v24, v25
    v_cvt_pk_bf16_f32 v237, v26, v27
    v_cvt_pk_bf16_f32 v238, v28, v29
    ds_write_b64 v250, v[236:237]
    v_cvt_pk_bf16_f32 v239, v30, v31
    ds_write_b64 v254, v[238:239]
    ds_read_b128 v[240:243], v251
    v_pk_fma_f32 v[32:33], v[32:33], v[212:213], v[220:221]
    v_pk_fma_f32 v[34:35], v[34:35], v[214:215], v[222:223]
    v_pk_fma_f32 v[36:37], v[36:37], v[216:217], v[224:225]
    v_pk_fma_f32 v[38:39], v[38:39], v[218:219], v[226:227]
    v_exp_f32 v228, v32
    v_exp_f32 v229, v33
    v_exp_f32 v230, v34
    v_exp_f32 v231, v35
    v_exp_f32 v232, v36
    v_exp_f32 v233, v37
    v_exp_f32 v234, v38
    v_exp_f32 v235, v39
    v_pk_fma_f32 v[228:229], v[228:229], s[46:47], s[46:47]
    s_waitcnt lgkmcnt(0)
    buffer_store_dwordx4 v[240:243], v10, s[28:31], 0 offen offset:1152 sc1
    v_pk_fma_f32 v[230:231], v[230:231], s[46:47], s[46:47]
    v_pk_fma_f32 v[232:233], v[232:233], s[46:47], s[46:47]
    v_pk_fma_f32 v[234:235], v[234:235], s[46:47], s[46:47]
    v_rcp_f32 v228, v228
    v_rcp_f32 v229, v229
    v_rcp_f32 v230, v230
    v_rcp_f32 v231, v231
    v_rcp_f32 v232, v232
    v_rcp_f32 v233, v233
    v_rcp_f32 v234, v234
    v_rcp_f32 v235, v235
    v_pk_mul_f32 v[32:33], v[32:33], v[228:229]
    v_pk_mul_f32 v[34:35], v[34:35], v[230:231]
    v_pk_mul_f32 v[36:37], v[36:37], v[232:233]
    v_pk_mul_f32 v[38:39], v[38:39], v[234:235]
    v_cvt_pk_bf16_f32 v236, v32, v33
    v_cvt_pk_bf16_f32 v237, v34, v35
    v_cvt_pk_bf16_f32 v238, v36, v37
    ds_write_b64 v250, v[236:237]
    v_cvt_pk_bf16_f32 v239, v38, v39
    ds_write_b64 v254, v[238:239]
    ds_read_b128 v[244:247], v251
    v_pk_fma_f32 v[48:49], v[48:49], v[212:213], v[220:221]
    v_pk_fma_f32 v[50:51], v[50:51], v[214:215], v[222:223]
    v_pk_fma_f32 v[52:53], v[52:53], v[216:217], v[224:225]
    v_pk_fma_f32 v[54:55], v[54:55], v[218:219], v[226:227]
    v_exp_f32 v228, v48
    v_exp_f32 v229, v49
    v_exp_f32 v230, v50
    v_exp_f32 v231, v51
    v_exp_f32 v232, v52
    v_exp_f32 v233, v53
    v_exp_f32 v234, v54
    v_exp_f32 v235, v55
    v_pk_fma_f32 v[228:229], v[228:229], s[46:47], s[46:47]
    s_waitcnt lgkmcnt(0)
    buffer_store_dwordx4 v[244:247], v10, s[28:31], 0 offen offset:2304 sc1
    v_pk_fma_f32 v[230:231], v[230:231], s[46:47], s[46:47]
    v_pk_fma_f32 v[232:233], v[232:233], s[46:47], s[46:47]
    v_pk_fma_f32 v[234:235], v[234:235], s[46:47], s[46:47]
    v_rcp_f32 v228, v228
    v_rcp_f32 v229, v229
    v_rcp_f32 v230, v230
    v_rcp_f32 v231, v231
    v_rcp_f32 v232, v232
    v_rcp_f32 v233, v233
    v_rcp_f32 v234, v234
    v_rcp_f32 v235, v235
    v_pk_mul_f32 v[48:49], v[48:49], v[228:229]
    v_pk_mul_f32 v[50:51], v[50:51], v[230:231]
    v_pk_mul_f32 v[52:53], v[52:53], v[232:233]
    v_pk_mul_f32 v[54:55], v[54:55], v[234:235]
    v_cvt_pk_bf16_f32 v236, v48, v49
    v_cvt_pk_bf16_f32 v237, v50, v51
    v_cvt_pk_bf16_f32 v238, v52, v53
    ds_write_b64 v250, v[236:237]
    v_cvt_pk_bf16_f32 v239, v54, v55
    ds_write_b64 v254, v[238:239]
    ds_read_b128 v[240:243], v251
    s_waitcnt lgkmcnt(0)
    buffer_store_dwordx4 v[240:243], v11, s[28:31], 0 offen sc1
    s_endpgm
L_end:
    s_endpgm
.section .rodata,"a"
.p2align 6
.amdhsa_kernel standalone__batchnorm__sampling_kernel
  .amdhsa_next_free_vgpr 256
  .amdhsa_next_free_sgpr 96
  .amdhsa_accum_offset 256
  .amdhsa_group_segment_fixed_size 0
  .amdhsa_kernarg_size 72
  .amdhsa_user_sgpr_count 2
  .amdhsa_user_sgpr_kernarg_segment_ptr 1
  .amdhsa_system_sgpr_workgroup_id_x 1
.end_amdhsa_kernel
```
